```python
import torch

def _softmax(x, axis=-1):
    return torch.softmax(x, dim=axis)
def _gelu(x):
    return torch.nn.functional.gelu(x, approximate="tanh")
def _silu(x):
    return torch.nn.functional.silu(x)
def _sigmoid(x):
    return torch.sigmoid(x)
def _layernorm(x, axis=-1, eps=1e-5):
    m = x.mean(dim=axis, keepdim=True)
    v = x.var(dim=axis, keepdim=True, unbiased=False)
    return (x - m) / torch.sqrt(v + eps)
def _scatter_add(tgt, idx, src, axis=0):
    return tgt.clone().index_add_(axis, idx, src)
def _segment_sum(src, seg, n):
    out = torch.zeros((n,) + src.shape[1:], dtype=src.dtype)
    return out.index_add_(0, seg, src)
def _pad(x, pw):
    flat = tuple(v for pair in reversed(pw) for v in pair)
    return torch.nn.functional.pad(x, flat)

kernel_name = 'standalone__adm_resblock__diffusion'

def setup_inputs():

    _w = (lambda a: (lambda t: t.to(torch.bfloat16) if t.is_floating_point() else t)(torch.as_tensor(a)))
    B, C, HW, E = 2, 512, 64, 768
    sc = (9.0 * C) ** -0.5
    return {
        "x": _w((lambda *s: torch.randn(*s, dtype=torch.bfloat16) * 0.05)(B, C, HW, HW)),
        "t_emb": _w((lambda *s: torch.randn(*s, dtype=torch.bfloat16) * 0.2)(B, E)),
        "g1": _w(1.0 + 0.1 * (lambda *s: torch.randn(*s, dtype=torch.bfloat16) * 0.2)(C)),
        "be1": _w(0.1 * (lambda *s: torch.randn(*s, dtype=torch.bfloat16) * 0.2)(C)),
        "w1": _w((lambda *s: torch.randn(*s, dtype=torch.bfloat16) * 0.2)(C, C, 3, 3) * sc),
        "w_emb": _w((lambda *s: torch.randn(*s, dtype=torch.bfloat16) * 0.2)(E, C) * (E ** -0.5)),
        "g2": _w(1.0 + 0.1 * (lambda *s: torch.randn(*s, dtype=torch.bfloat16) * 0.2)(C)),
        "be2": _w(0.1 * (lambda *s: torch.randn(*s, dtype=torch.bfloat16) * 0.2)(C)),
        "w2": _w((lambda *s: torch.randn(*s, dtype=torch.bfloat16) * 0.2)(C, C, 3, 3) * sc),
    }

def reference(x, t_emb, g1, be1, w1, w_emb, g2, be2, w2):
    B, C, H, W = x.shape
    G, eps = 4, 1e-5
    def gn(z, gamma, beta):
        zr = z.reshape(B, G, (C // G) * H * W)
        mu = zr.mean(-1).reshape(B, G, 1)
        var = ((zr - mu) ** 2).mean(-1).reshape(B, G, 1)
        zn = ((zr - mu) / torch.sqrt(var + eps)).reshape(B, C, H, W)
        return zn * gamma.reshape(1, C, 1, 1) + beta.reshape(1, C, 1, 1)
    def conv3(z, w):
        zp = _pad(z, ((0, 0), (0, 0), (1, 1), (1, 1)))
        taps = [torch.einsum("bchw,oc->bohw", zp[:, :, i:i+H, j:j+W], w[:, :, i, j]) for i in range(3) for j in range(3)]
        out = taps[0]
        for t in taps[1:]:
            out = out + t
        return out
    h = conv3(_silu(gn(x, g1, be1)), w1)
    emb = _silu(t_emb) @ w_emb
    h = h + emb.reshape(B, C, 1, 1)
    h = conv3(_silu(gn(h, g2, be2)), w2)
    return x + h
```

```asm
; @launch grid=(256,1,1) block=(512,1,1) lds=152128
.amdgcn_target "amdgcn-amd-amdhsa--gfx950"
.text
.globl standalone__adm_resblock__diffusion_kernel
.p2align 8
.type standalone__adm_resblock__diffusion_kernel,@function
standalone__adm_resblock__diffusion_kernel:
    s_cmp_ge_u32 s2, 256
    s_cbranch_scc1 L_end
    s_load_dwordx16 s[64:79], s[0:1], 0
    s_load_dwordx8 s[80:87], s[0:1], 64
    v_lshrrev_b32 v1, 6, v0
    v_and_b32 v2, 63, v0
    v_readfirstlane_b32 s43, v1
    v_lshlrev_b32 v6, 4, v2
    v_and_b32 v8, 15, v2
    v_lshrrev_b32 v9, 4, v2
    v_mov_b32 v14, 0
    s_getpc_b64 s[12:13]
L_pc:
    s_sub_u32 s12, s12, L_pc-standalone__adm_resblock__diffusion_kernel
    s_subb_u32 s13, s13, 0
    s_mov_b32 s14, L_codeend-standalone__adm_resblock__diffusion_kernel
    s_mov_b32 s15, 0x20000
    s_lshr_b32 s3, s2, 3
    s_lshl_b32 s4, s43, 4
    s_add_u32 s3, s3, s4
    s_and_b32 s3, s3, 31
    s_lshl_b32 s3, s3, 10
    s_cmp_lt_u32 s43, 6
    s_cbranch_scc1 L_nocpf
    buffer_load_dwordx4 v[104:107], v6, s[12:15], s3 offen
L_nocpf:
    s_and_b32 s3, s2, 1
    s_lshl_b32 s3, s3, 2
    s_bfe_u32 s4, s2, 0x20003
    s_add_u32 s40, s3, s4
    s_bfe_u32 s3, s2, 0x20001
    s_lshl_b32 s3, s3, 3
    s_lshr_b32 s4, s2, 5
    s_add_u32 s44, s3, s4
    s_lshr_b32 s41, s44, 4
    s_and_b32 s42, s44, 15
    v_and_b32 v3, 3, v2
    v_lshrrev_b32 v4, 2, v2
    v_lshlrev_b32 v5, 16, v3
    v_lshl_add_u32 v5, v4, 3, v5
    s_lshl_b32 s47, s41, 22
    s_lshl_b32 s3, s40, 19
    s_add_u32 s47, s47, s3
    s_lshl_b32 s3, s42, 9
    s_add_u32 s47, s47, s3
    s_lshr_b32 s45, s43, 2
    s_and_b32 s46, s43, 3
    s_memrealtime s[4:5]
    s_waitcnt lgkmcnt(0)
    s_lshl_b32 s3, s2, 3
    s_add_u32 s3, s3, s43
    s_cmp_lg_u32 s3, 7
    s_cbranch_scc1 L_nononce
    s_mov_b32 s32, s84
    s_mov_b32 s33, s85
    s_mov_b32 s34, 0x100
    s_mov_b32 s35, 0x20000
    s_or_b32 s4, s4, 1
    v_mov_b32 v13, s4
    s_mov_b64 exec, 1
    buffer_store_dword v13, v14, s[32:35], 0 offen sc0 sc1
    s_mov_b64 exec, -1
L_nononce:
    s_mov_b32 s8, s64
    s_mov_b32 s9, s65
    s_mov_b32 s10, 0x800000
    s_mov_b32 s11, 0x20000
    s_lshl_b32 s3, s45, 18
    s_lshl_b32 s4, s46, 7
    s_add_u32 s3, s3, s4
    s_add_u32 s3, s3, s47
    buffer_load_dwordx2 v[48:49], v5, s[8:11], s3 offen nt
    s_add_u32 s3, s3, 8192
    buffer_load_dwordx2 v[50:51], v5, s[8:11], s3 offen nt
    s_add_u32 s3, s3, 8192
    buffer_load_dwordx2 v[52:53], v5, s[8:11], s3 offen nt
    s_add_u32 s3, s3, 8192
    buffer_load_dwordx2 v[54:55], v5, s[8:11], s3 offen nt
    s_add_u32 s3, s3, 8192
    buffer_load_dwordx2 v[56:57], v5, s[8:11], s3 offen nt
    s_add_u32 s3, s3, 8192
    buffer_load_dwordx2 v[58:59], v5, s[8:11], s3 offen nt
    s_add_u32 s3, s3, 8192
    buffer_load_dwordx2 v[60:61], v5, s[8:11], s3 offen nt
    s_add_u32 s3, s3, 8192
    buffer_load_dwordx2 v[62:63], v5, s[8:11], s3 offen nt
    s_add_u32 s6, s64, s47
    s_addc_u32 s7, s65, 0
    s_load_dword s48, s[6:7], 0
    s_mov_b32 s24, s68
    s_mov_b32 s25, s69
    s_mov_b32 s26, 0x400
    s_mov_b32 s27, 0x20000
    s_mov_b32 s28, s70
    s_mov_b32 s29, s71
    s_mov_b32 s30, 0x400
    s_mov_b32 s31, 0x20000
    s_lshl_b32 s3, s40, 7
    s_lshl_b32 s4, s45, 6
    s_add_u32 s3, s3, s4
    v_lshlrev_b32 v10, 4, v3
    buffer_load_dwordx4 v[64:67], v10, s[24:27], s3 offen
    buffer_load_dwordx4 v[68:71], v10, s[28:31], s3 offen
    s_add_u32 s20, s86, 0x2000000
    s_addc_u32 s21, s87, 0
    s_mov_b32 s22, 0x28000
    s_mov_b32 s23, 0x20000
    s_mov_b32 s93, 0xbfb8aa3b
    s_mov_b32 s89, 0
    s_mov_b32 s88, 0
    v_mov_b32 v10, 133408
    v_mov_b32 v12, 0
    v_mov_b32 v13, 0
    ds_write_b64 v10, v[12:13]
    s_waitcnt lgkmcnt(0)
    s_barrier
    s_lshl_b32 s36, s40, 2
    s_lshr_b32 s3, s44, 3
    s_add_u32 s36, s36, s3
    s_and_b32 s37, s44, 7
    s_cmp_eq_u32 s43, 0
    s_cbranch_scc1 L_r0
    s_cmp_eq_u32 s43, 1
    s_cbranch_scc1 L_r1
    s_cmp_lt_u32 s43, 4
    s_cbranch_scc1 L_rw
    s_cmp_gt_u32 s43, 5
    s_cbranch_scc1 L_rw2
    s_cmp_lg_u32 s43, 4
    s_cbranch_scc1 L_rnone
    s_bitcmp1_b32 s44, 0
    s_cbranch_scc1 L_rnone
    s_lshr_b32 s49, s44, 1
    s_mul_i32 s3, s49, 48
    v_lshrrev_b32 v10, 3, v2
    v_mul_u32_u24 v10, 6, v10
    v_add_u32 v10, s3, v10
    v_lshlrev_b32 v11, 1, v10
    v_lshlrev_b32 v10, 10, v10
    v_and_b32 v12, 7, v2
    v_lshl_add_u32 v10, v12, 4, v10
    v_add_u32 v12, 4096, v10
    s_lshl_b32 s3, s40, 7
    s_mov_b32 s12, s66
    s_mov_b32 s13, s67
    s_mov_b32 s14, 0xc00
    s_mov_b32 s15, 0x20000
    s_mov_b32 s16, s74
    s_mov_b32 s17, s75
    s_mov_b32 s18, 0xc0000
    s_mov_b32 s19, 0x20000
    buffer_load_dwordx3 v[112:114], v11, s[12:15], 0 offen
    buffer_load_dwordx3 v[116:118], v11, s[12:15], 0 offen offset:1536
    buffer_load_dwordx4 v[120:123], v10, s[16:19], s3 offen offset:0 nt
    buffer_load_dwordx4 v[124:127], v10, s[16:19], s3 offen offset:1024 nt
    buffer_load_dwordx4 v[128:131], v10, s[16:19], s3 offen offset:2048 nt
    buffer_load_dwordx4 v[132:135], v10, s[16:19], s3 offen offset:3072 nt
    buffer_load_dwordx4 v[136:139], v12, s[16:19], s3 offen offset:0 nt
    buffer_load_dwordx4 v[140:143], v12, s[16:19], s3 offen offset:1024 nt
    s_waitcnt vmcnt(8)
    s_branch L_rdone
L_rw:
    s_sub_u32 s51, s43, 2
    s_lshl_b32 s50, s37, 1
    s_add_u32 s50, s50, s51
    s_mul_i32 s51, s51, 9216
    s_add_u32 s51, s51, 0
    s_mov_b32 s12, s72
    s_mov_b32 s13, s73
    s_mov_b32 s14, 0x480000
    s_mov_b32 s15, 0x20000
    v_lshlrev_b32 v10, 3, v9
    v_bfe_u32 v11, v2, 2, 2
    v_add_u32 v10, v10, v11
    v_mul_u32_u24 v10, 9216, v10
    v_and_b32 v11, 3, v2
    v_lshl_add_u32 v10, v11, 4, v10
    s_lshr_b32 s3, s36, 1
    s_lshl_b32 s3, s3, 5
    s_and_b32 s4, s36, 1
    s_lshl_b32 s4, s4, 2
    s_add_u32 s3, s3, s4
    s_mul_i32 s3, s3, 9216
    s_mul_i32 s4, s50, 576
    s_add_u32 s3, s3, s4
    s_add_u32 m0, s51, 0
    s_nop 0
    buffer_load_dwordx4 v10, s[12:15], s3 offen offset:0 nt lds
    s_add_u32 m0, s51, 960
    s_nop 0
    buffer_load_dwordx4 v10, s[12:15], s3 offen offset:64 nt lds
    s_add_u32 m0, s51, 1920
    s_nop 0
    buffer_load_dwordx4 v10, s[12:15], s3 offen offset:128 nt lds
    s_add_u32 m0, s51, 2880
    s_nop 0
    buffer_load_dwordx4 v10, s[12:15], s3 offen offset:192 nt lds
    s_add_u32 m0, s51, 3840
    s_nop 0
    buffer_load_dwordx4 v10, s[12:15], s3 offen offset:256 nt lds
    s_add_u32 m0, s51, 4800
    s_nop 0
    buffer_load_dwordx4 v10, s[12:15], s3 offen offset:320 nt lds
    s_add_u32 m0, s51, 5760
    s_nop 0
    buffer_load_dwordx4 v10, s[12:15], s3 offen offset:384 nt lds
    s_add_u32 m0, s51, 6720
    s_nop 0
    buffer_load_dwordx4 v10, s[12:15], s3 offen offset:448 nt lds
    s_add_u32 m0, s51, 7680
    s_nop 0
    buffer_load_dwordx4 v10, s[12:15], s3 offen offset:512 nt lds
    s_waitcnt vmcnt(9)
    s_branch L_rdone
L_rw2:
    s_sub_u32 s51, s43, 6
    s_lshl_b32 s50, s37, 1
    s_add_u32 s50, s50, s51
    s_mul_i32 s51, s51, 9216
    s_add_u32 s51, s51, 133696
    s_waitcnt vmcnt(10)
    s_mov_b32 s12, s80
    s_mov_b32 s13, s81
    s_mov_b32 s14, 0x480000
    s_mov_b32 s15, 0x20000
    v_lshlrev_b32 v10, 3, v9
    v_bfe_u32 v11, v2, 2, 2
    v_add_u32 v10, v10, v11
    v_mul_u32_u24 v10, 9216, v10
    v_and_b32 v11, 3, v2
    v_lshl_add_u32 v10, v11, 4, v10
    s_lshr_b32 s3, s36, 1
    s_lshl_b32 s3, s3, 5
    s_and_b32 s4, s36, 1
    s_lshl_b32 s4, s4, 2
    s_add_u32 s3, s3, s4
    s_mul_i32 s3, s3, 9216
    s_mul_i32 s4, s50, 576
    s_add_u32 s3, s3, s4
    s_add_u32 m0, s51, 0
    s_nop 0
    buffer_load_dwordx4 v10, s[12:15], s3 offen offset:0 nt lds
    s_add_u32 m0, s51, 960
    s_nop 0
    buffer_load_dwordx4 v10, s[12:15], s3 offen offset:64 nt lds
    s_add_u32 m0, s51, 1920
    s_nop 0
    buffer_load_dwordx4 v10, s[12:15], s3 offen offset:128 nt lds
    s_add_u32 m0, s51, 2880
    s_nop 0
    buffer_load_dwordx4 v10, s[12:15], s3 offen offset:192 nt lds
    s_add_u32 m0, s51, 3840
    s_nop 0
    buffer_load_dwordx4 v10, s[12:15], s3 offen offset:256 nt lds
    s_add_u32 m0, s51, 4800
    s_nop 0
    buffer_load_dwordx4 v10, s[12:15], s3 offen offset:320 nt lds
    s_add_u32 m0, s51, 5760
    s_nop 0
    buffer_load_dwordx4 v10, s[12:15], s3 offen offset:384 nt lds
    s_add_u32 m0, s51, 6720
    s_nop 0
    buffer_load_dwordx4 v10, s[12:15], s3 offen offset:448 nt lds
    s_add_u32 m0, s51, 7680
    s_nop 0
    buffer_load_dwordx4 v10, s[12:15], s3 offen offset:512 nt lds
    s_waitcnt vmcnt(9)
    s_branch L_rdone
L_r1:
    s_mov_b32 s12, s76
    s_mov_b32 s13, s77
    s_mov_b32 s14, 0x400
    s_mov_b32 s15, 0x20000
    s_mov_b32 s16, s78
    s_mov_b32 s17, s79
    s_mov_b32 s18, 0x400
    s_mov_b32 s19, 0x20000
    buffer_load_dwordx4 v[112:115], v6, s[24:27], 0 offen
    buffer_load_dwordx4 v[116:119], v6, s[28:31], 0 offen
    buffer_load_dwordx4 v[120:123], v6, s[12:15], 0 offen
    buffer_load_dwordx4 v[124:127], v6, s[16:19], 0 offen
    s_waitcnt vmcnt(4)
    s_branch L_rdone
L_r0:
    s_mov_b32 s32, s84
    s_mov_b32 s33, s85
    s_mov_b32 s34, 0x100
    s_mov_b32 s35, 0x20000
    s_waitcnt vmcnt(8)
    buffer_load_dword v112, v14, s[32:35], 0 offen sc0 sc1
    s_waitcnt vmcnt(1)
    s_branch L_rdone
L_rnone:
    s_waitcnt vmcnt(0)
L_rdone:
    v_lshlrev_b32 v72, 16, v48
    v_and_b32 v73, 0xffff0000, v48
    v_lshlrev_b32 v74, 16, v49
    v_and_b32 v75, 0xffff0000, v49
    v_lshlrev_b32 v76, 16, v50
    v_and_b32 v77, 0xffff0000, v50
    v_lshlrev_b32 v78, 16, v51
    v_and_b32 v79, 0xffff0000, v51
    v_lshlrev_b32 v80, 16, v52
    v_and_b32 v81, 0xffff0000, v52
    v_lshlrev_b32 v82, 16, v53
    v_and_b32 v83, 0xffff0000, v53
    v_lshlrev_b32 v84, 16, v54
    v_and_b32 v85, 0xffff0000, v54
    v_lshlrev_b32 v86, 16, v55
    v_and_b32 v87, 0xffff0000, v55
    v_lshlrev_b32 v88, 16, v56
    v_and_b32 v89, 0xffff0000, v56
    v_lshlrev_b32 v90, 16, v57
    v_and_b32 v91, 0xffff0000, v57
    v_lshlrev_b32 v92, 16, v58
    v_and_b32 v93, 0xffff0000, v58
    v_lshlrev_b32 v94, 16, v59
    v_and_b32 v95, 0xffff0000, v59
    v_lshlrev_b32 v96, 16, v60
    v_and_b32 v97, 0xffff0000, v60
    v_lshlrev_b32 v98, 16, v61
    v_and_b32 v99, 0xffff0000, v61
    v_lshlrev_b32 v100, 16, v62
    v_and_b32 v101, 0xffff0000, v62
    v_lshlrev_b32 v102, 16, v63
    v_and_b32 v103, 0xffff0000, v63
    s_waitcnt lgkmcnt(0)
    s_lshl_b32 s48, s48, 16
    v_mov_b32 v20, s48
    v_pk_add_f32 v[72:73], v[72:73], s[48:49] op_sel_hi:[1,0] neg_lo:[0,1] neg_hi:[0,1]
    v_pk_add_f32 v[74:75], v[74:75], s[48:49] op_sel_hi:[1,0] neg_lo:[0,1] neg_hi:[0,1]
    v_pk_add_f32 v[76:77], v[76:77], s[48:49] op_sel_hi:[1,0] neg_lo:[0,1] neg_hi:[0,1]
    v_pk_add_f32 v[78:79], v[78:79], s[48:49] op_sel_hi:[1,0] neg_lo:[0,1] neg_hi:[0,1]
    v_pk_add_f32 v[80:81], v[80:81], s[48:49] op_sel_hi:[1,0] neg_lo:[0,1] neg_hi:[0,1]
    v_pk_add_f32 v[82:83], v[82:83], s[48:49] op_sel_hi:[1,0] neg_lo:[0,1] neg_hi:[0,1]
    v_pk_add_f32 v[84:85], v[84:85], s[48:49] op_sel_hi:[1,0] neg_lo:[0,1] neg_hi:[0,1]
    v_pk_add_f32 v[86:87], v[86:87], s[48:49] op_sel_hi:[1,0] neg_lo:[0,1] neg_hi:[0,1]
    v_pk_add_f32 v[88:89], v[88:89], s[48:49] op_sel_hi:[1,0] neg_lo:[0,1] neg_hi:[0,1]
    v_pk_add_f32 v[90:91], v[90:91], s[48:49] op_sel_hi:[1,0] neg_lo:[0,1] neg_hi:[0,1]
    v_pk_add_f32 v[92:93], v[92:93], s[48:49] op_sel_hi:[1,0] neg_lo:[0,1] neg_hi:[0,1]
    v_pk_add_f32 v[94:95], v[94:95], s[48:49] op_sel_hi:[1,0] neg_lo:[0,1] neg_hi:[0,1]
    v_pk_add_f32 v[96:97], v[96:97], s[48:49] op_sel_hi:[1,0] neg_lo:[0,1] neg_hi:[0,1]
    v_pk_add_f32 v[98:99], v[98:99], s[48:49] op_sel_hi:[1,0] neg_lo:[0,1] neg_hi:[0,1]
    v_pk_add_f32 v[100:101], v[100:101], s[48:49] op_sel_hi:[1,0] neg_lo:[0,1] neg_hi:[0,1]
    v_pk_add_f32 v[102:103], v[102:103], s[48:49] op_sel_hi:[1,0] neg_lo:[0,1] neg_hi:[0,1]
    v_pk_add_f32 v[24:25], v[72:73], v[76:77]
    v_pk_mul_f32 v[26:27], v[72:73], v[72:73]
    v_pk_add_f32 v[28:29], v[74:75], v[78:79]
    v_pk_mul_f32 v[30:31], v[74:75], v[74:75]
    v_pk_fma_f32 v[26:27], v[76:77], v[76:77], v[26:27]
    v_pk_fma_f32 v[30:31], v[78:79], v[78:79], v[30:31]
    v_pk_add_f32 v[24:25], v[24:25], v[80:81]
    v_pk_fma_f32 v[26:27], v[80:81], v[80:81], v[26:27]
    v_pk_add_f32 v[28:29], v[28:29], v[82:83]
    v_pk_fma_f32 v[30:31], v[82:83], v[82:83], v[30:31]
    v_pk_add_f32 v[24:25], v[24:25], v[84:85]
    v_pk_fma_f32 v[26:27], v[84:85], v[84:85], v[26:27]
    v_pk_add_f32 v[28:29], v[28:29], v[86:87]
    v_pk_fma_f32 v[30:31], v[86:87], v[86:87], v[30:31]
    v_pk_add_f32 v[24:25], v[24:25], v[88:89]
    v_pk_fma_f32 v[26:27], v[88:89], v[88:89], v[26:27]
    v_pk_add_f32 v[28:29], v[28:29], v[90:91]
    v_pk_fma_f32 v[30:31], v[90:91], v[90:91], v[30:31]
    v_pk_add_f32 v[24:25], v[24:25], v[92:93]
    v_pk_fma_f32 v[26:27], v[92:93], v[92:93], v[26:27]
    v_pk_add_f32 v[28:29], v[28:29], v[94:95]
    v_pk_fma_f32 v[30:31], v[94:95], v[94:95], v[30:31]
    v_pk_add_f32 v[24:25], v[24:25], v[96:97]
    v_pk_fma_f32 v[26:27], v[96:97], v[96:97], v[26:27]
    v_pk_add_f32 v[28:29], v[28:29], v[98:99]
    v_pk_fma_f32 v[30:31], v[98:99], v[98:99], v[30:31]
    v_pk_add_f32 v[24:25], v[24:25], v[100:101]
    v_pk_fma_f32 v[26:27], v[100:101], v[100:101], v[26:27]
    v_pk_add_f32 v[28:29], v[28:29], v[102:103]
    v_pk_fma_f32 v[30:31], v[102:103], v[102:103], v[30:31]
    v_pk_add_f32 v[24:25], v[24:25], v[28:29]
    v_pk_add_f32 v[26:27], v[26:27], v[30:31]
    v_add_f32 v24, v24, v25
    v_add_f32 v25, v26, v27
    s_nop 1
    v_add_f32_dpp v24, v24, v24 quad_perm:[1,0,3,2] row_mask:0xf bank_mask:0xf
    v_add_f32_dpp v25, v25, v25 quad_perm:[1,0,3,2] row_mask:0xf bank_mask:0xf
    s_nop 0
    v_add_f32_dpp v24, v24, v24 quad_perm:[2,3,0,1] row_mask:0xf bank_mask:0xf
    v_add_f32_dpp v25, v25, v25 quad_perm:[2,3,0,1] row_mask:0xf bank_mask:0xf
    s_nop 0
    v_add_f32_dpp v24, v24, v24 row_half_mirror row_mask:0xf bank_mask:0xf
    v_add_f32_dpp v25, v25, v25 row_half_mirror row_mask:0xf bank_mask:0xf
    s_nop 0
    v_add_f32_dpp v24, v24, v24 row_mirror row_mask:0xf bank_mask:0xf
    v_add_f32_dpp v25, v25, v25 row_mirror row_mask:0xf bank_mask:0xf
    s_nop 0
    s_lshl_b32 s3, s43, 5
    s_add_u32 s3, s3, 133120
    v_lshl_add_u32 v12, v9, 3, s3
    ds_write_b64 v12, v[24:25]
    s_waitcnt lgkmcnt(0)
    s_barrier
    s_cmp_eq_u32 s43, 0
    s_cbranch_scc1 L_s0
    s_mul_i32 s3, s45, 16896
    s_lshl_b32 s4, s46, 7
    s_add_u32 s3, s3, s4
    s_add_u32 s3, s3, 20480
    v_mul_u32_u24 v10, 4224, v3
    v_lshl_add_u32 v10, v4, 3, v10
    v_add_u32 v10, s3, v10
    ds_write_b64 v10, v[48:49] offset:0
    ds_write_b64 v10, v[50:51] offset:512
    ds_write_b64 v10, v[52:53] offset:1024
    ds_write_b64 v10, v[54:55] offset:1536
    ds_write_b64 v10, v[56:57] offset:2048
    ds_write_b64 v10, v[58:59] offset:2560
    ds_write_b64 v10, v[60:61] offset:3072
    ds_write_b64 v10, v[62:63] offset:3584
    s_cmp_eq_u32 s43, 4
    s_cbranch_scc1 L_semb
    s_and_b32 s3, s43, 6
    s_cmp_lg_u32 s3, 2
    s_cbranch_scc1 L_nww
    s_lshl_b32 s3, s43, 2
    s_add_u32 s3, s3, 133400
    v_mov_b32 v10, s3
    v_mov_b32 v11, 1
    s_waitcnt vmcnt(0)
    ds_write_b32 v10, v11
L_nww:
    s_lshl_b32 s3, s45, 2
    s_add_u32 s3, s3, 133408
    v_mov_b32 v10, s3
L_wspin:
    ds_read_b32 v11, v10
    s_waitcnt lgkmcnt(0)
    v_readfirstlane_b32 s3, v11
    s_nop 3
    s_cmp_lg_u32 s3, 0
    s_cbranch_scc1 L_wok
    s_sleep 1
    s_branch L_wspin
L_wok:
    s_lshr_b32 s5, s43, 2
    s_mul_i32 s3, s5, 9216
    s_add_u32 s3, s3, 0
    v_mul_u32_u24 v180, 9, v9
    v_lshl_add_u32 v181, v8, 6, s3
    v_add_u32 v182, 0, v180
    v_lshrrev_b32 v183, 2, v182
    v_and_b32 v182, 3, v182
    v_lshl_add_u32 v183, v183, 10, v181
    v_lshl_add_u32 v10, v182, 4, v183
    v_add_u32 v182, 1, v180
    v_lshrrev_b32 v183, 2, v182
    v_and_b32 v182, 3, v182
    v_lshl_add_u32 v183, v183, 10, v181
    v_lshl_add_u32 v11, v182, 4, v183
    v_add_u32 v182, 2, v180
    v_lshrrev_b32 v183, 2, v182
    v_and_b32 v182, 3, v182
    v_lshl_add_u32 v183, v183, 10, v181
    v_lshl_add_u32 v12, v182, 4, v183
    v_add_u32 v182, 3, v180
    v_lshrrev_b32 v183, 2, v182
    v_and_b32 v182, 3, v182
    v_lshl_add_u32 v183, v183, 10, v181
    v_lshl_add_u32 v13, v182, 4, v183
    ds_read_b128 v[144:147], v10 offset:0
    ds_read_b128 v[148:151], v11 offset:0
    ds_read_b128 v[152:155], v12 offset:0
    ds_read_b128 v[156:159], v13 offset:0
    ds_read_b128 v[160:163], v10 offset:1024
    ds_read_b128 v[164:167], v11 offset:1024
    ds_read_b128 v[168:171], v12 offset:1024
    ds_read_b128 v[172:175], v13 offset:1024
    ds_read_b128 v[176:179], v10 offset:2048
    s_lshr_b32 s3, s36, 2
    s_mul_i32 s3, s3, 786432
    s_lshl_b32 s4, s37, 1
    s_add_u32 s4, s4, s5
    s_lshl_b32 s4, s4, 2
    s_and_b32 s5, s36, 3
    s_add_u32 s4, s4, s5
    s_mul_i32 s4, s4, 3
    s_and_b32 s5, s43, 3
    s_add_u32 s4, s4, s5
    s_sub_u32 s4, s4, 1
    s_lshl_b32 s4, s4, 10
    s_add_u32 s39, s3, s4
    s_mov_b32 s6, 0x07060100
    s_mov_b32 s7, 0x05040302
    s_waitcnt lgkmcnt(0)
    s_cmp_eq_u32 s5, 2
    s_cbranch_scc1 L_wp_2
    s_cmp_eq_u32 s5, 3
    s_cbranch_scc1 L_wp_3
L_wp_1:
    v_perm_b32 v190, v148, v144, s6
    v_perm_b32 v191, v157, v153, s6
    v_perm_b32 v192, v166, v162, s6
    v_perm_b32 v193, v175, v171, s6
    v_perm_b32 v202, v151, v147, s6
    v_perm_b32 v203, v160, v156, s6
    v_perm_b32 v204, v169, v165, s6
    v_perm_b32 v205, v178, v174, s6
    v_lshlrev_b32 v180, 16, v144
    v_and_b32 v181, 0xffff0000, v145
    v_lshlrev_b32 v182, 16, v147
    v_and_b32 v183, 0xffff0000, v148
    v_lshlrev_b32 v184, 16, v150
    v_and_b32 v185, 0xffff0000, v151
    v_add_f32 v180, v180, v182
    v_add_f32 v183, v183, v185
    v_add_f32 v186, v180, v181
    v_sub_f32 v188, v180, v181
    v_add_f32 v187, v183, v184
    v_sub_f32 v189, v183, v184
    v_cvt_pk_bf16_f32 v194, v186, v187
    v_cvt_pk_bf16_f32 v198, v188, v189
    v_lshlrev_b32 v180, 16, v153
    v_and_b32 v181, 0xffff0000, v154
    v_lshlrev_b32 v182, 16, v156
    v_and_b32 v183, 0xffff0000, v157
    v_lshlrev_b32 v184, 16, v159
    v_and_b32 v185, 0xffff0000, v160
    v_add_f32 v180, v180, v182
    v_add_f32 v183, v183, v185
    v_add_f32 v186, v180, v181
    v_sub_f32 v188, v180, v181
    v_add_f32 v187, v183, v184
    v_sub_f32 v189, v183, v184
    v_cvt_pk_bf16_f32 v195, v186, v187
    v_cvt_pk_bf16_f32 v199, v188, v189
    v_lshlrev_b32 v180, 16, v162
    v_and_b32 v181, 0xffff0000, v163
    v_lshlrev_b32 v182, 16, v165
    v_and_b32 v183, 0xffff0000, v166
    v_lshlrev_b32 v184, 16, v168
    v_and_b32 v185, 0xffff0000, v169
    v_add_f32 v180, v180, v182
    v_add_f32 v183, v183, v185
    v_add_f32 v186, v180, v181
    v_sub_f32 v188, v180, v181
    v_add_f32 v187, v183, v184
    v_sub_f32 v189, v183, v184
    v_cvt_pk_bf16_f32 v196, v186, v187
    v_cvt_pk_bf16_f32 v200, v188, v189
    v_lshlrev_b32 v180, 16, v171
    v_and_b32 v181, 0xffff0000, v172
    v_lshlrev_b32 v182, 16, v174
    v_and_b32 v183, 0xffff0000, v175
    v_lshlrev_b32 v184, 16, v177
    v_and_b32 v185, 0xffff0000, v178
    v_add_f32 v180, v180, v182
    v_add_f32 v183, v183, v185
    v_add_f32 v186, v180, v181
    v_sub_f32 v188, v180, v181
    v_add_f32 v187, v183, v184
    v_sub_f32 v189, v183, v184
    v_cvt_pk_bf16_f32 v197, v186, v187
    v_cvt_pk_bf16_f32 v201, v188, v189
    s_branch L_wp_4
L_wp_2:
    v_perm_b32 v190, v149, v144, s7
    v_perm_b32 v191, v158, v153, s7
    v_perm_b32 v192, v167, v162, s7
    v_perm_b32 v193, v176, v171, s7
    v_perm_b32 v202, v152, v147, s7
    v_perm_b32 v203, v161, v156, s7
    v_perm_b32 v204, v170, v165, s7
    v_perm_b32 v205, v179, v174, s7
    v_and_b32 v180, 0xffff0000, v144
    v_lshlrev_b32 v181, 16, v146
    v_and_b32 v182, 0xffff0000, v147
    v_lshlrev_b32 v183, 16, v149
    v_and_b32 v184, 0xffff0000, v150
    v_lshlrev_b32 v185, 16, v152
    v_add_f32 v180, v180, v182
    v_add_f32 v183, v183, v185
    v_add_f32 v186, v180, v181
    v_sub_f32 v188, v180, v181
    v_add_f32 v187, v183, v184
    v_sub_f32 v189, v183, v184
    v_cvt_pk_bf16_f32 v194, v186, v187
    v_cvt_pk_bf16_f32 v198, v188, v189
    v_and_b32 v180, 0xffff0000, v153
    v_lshlrev_b32 v181, 16, v155
    v_and_b32 v182, 0xffff0000, v156
    v_lshlrev_b32 v183, 16, v158
    v_and_b32 v184, 0xffff0000, v159
    v_lshlrev_b32 v185, 16, v161
    v_add_f32 v180, v180, v182
    v_add_f32 v183, v183, v185
    v_add_f32 v186, v180, v181
    v_sub_f32 v188, v180, v181
    v_add_f32 v187, v183, v184
    v_sub_f32 v189, v183, v184
    v_cvt_pk_bf16_f32 v195, v186, v187
    v_cvt_pk_bf16_f32 v199, v188, v189
    v_and_b32 v180, 0xffff0000, v162
    v_lshlrev_b32 v181, 16, v164
    v_and_b32 v182, 0xffff0000, v165
    v_lshlrev_b32 v183, 16, v167
    v_and_b32 v184, 0xffff0000, v168
    v_lshlrev_b32 v185, 16, v170
    v_add_f32 v180, v180, v182
    v_add_f32 v183, v183, v185
    v_add_f32 v186, v180, v181
    v_sub_f32 v188, v180, v181
    v_add_f32 v187, v183, v184
    v_sub_f32 v189, v183, v184
    v_cvt_pk_bf16_f32 v196, v186, v187
    v_cvt_pk_bf16_f32 v200, v188, v189
    v_and_b32 v180, 0xffff0000, v171
    v_lshlrev_b32 v181, 16, v173
    v_and_b32 v182, 0xffff0000, v174
    v_lshlrev_b32 v183, 16, v176
    v_and_b32 v184, 0xffff0000, v177
    v_lshlrev_b32 v185, 16, v179
    v_add_f32 v180, v180, v182
    v_add_f32 v183, v183, v185
    v_add_f32 v186, v180, v181
    v_sub_f32 v188, v180, v181
    v_add_f32 v187, v183, v184
    v_sub_f32 v189, v183, v184
    v_cvt_pk_bf16_f32 v197, v186, v187
    v_cvt_pk_bf16_f32 v201, v188, v189
    s_branch L_wp_4
L_wp_3:
    v_perm_b32 v190, v149, v145, s6
    v_perm_b32 v191, v158, v154, s6
    v_perm_b32 v192, v167, v163, s6
    v_perm_b32 v193, v176, v172, s6
    v_perm_b32 v202, v152, v148, s6
    v_perm_b32 v203, v161, v157, s6
    v_perm_b32 v204, v170, v166, s6
    v_perm_b32 v205, v179, v175, s6
    v_lshlrev_b32 v180, 16, v145
    v_and_b32 v181, 0xffff0000, v146
    v_lshlrev_b32 v182, 16, v148
    v_and_b32 v183, 0xffff0000, v149
    v_lshlrev_b32 v184, 16, v151
    v_and_b32 v185, 0xffff0000, v152
    v_add_f32 v180, v180, v182
    v_add_f32 v183, v183, v185
    v_add_f32 v186, v180, v181
    v_sub_f32 v188, v180, v181
    v_add_f32 v187, v183, v184
    v_sub_f32 v189, v183, v184
    v_cvt_pk_bf16_f32 v194, v186, v187
    v_cvt_pk_bf16_f32 v198, v188, v189
    v_lshlrev_b32 v180, 16, v154
    v_and_b32 v181, 0xffff0000, v155
    v_lshlrev_b32 v182, 16, v157
    v_and_b32 v183, 0xffff0000, v158
    v_lshlrev_b32 v184, 16, v160
    v_and_b32 v185, 0xffff0000, v161
    v_add_f32 v180, v180, v182
    v_add_f32 v183, v183, v185
    v_add_f32 v186, v180, v181
    v_sub_f32 v188, v180, v181
    v_add_f32 v187, v183, v184
    v_sub_f32 v189, v183, v184
    v_cvt_pk_bf16_f32 v195, v186, v187
    v_cvt_pk_bf16_f32 v199, v188, v189
    v_lshlrev_b32 v180, 16, v163
    v_and_b32 v181, 0xffff0000, v164
    v_lshlrev_b32 v182, 16, v166
    v_and_b32 v183, 0xffff0000, v167
    v_lshlrev_b32 v184, 16, v169
    v_and_b32 v185, 0xffff0000, v170
    v_add_f32 v180, v180, v182
    v_add_f32 v183, v183, v185
    v_add_f32 v186, v180, v181
    v_sub_f32 v188, v180, v181
    v_add_f32 v187, v183, v184
    v_sub_f32 v189, v183, v184
    v_cvt_pk_bf16_f32 v196, v186, v187
    v_cvt_pk_bf16_f32 v200, v188, v189
    v_lshlrev_b32 v180, 16, v172
    v_and_b32 v181, 0xffff0000, v173
    v_lshlrev_b32 v182, 16, v175
    v_and_b32 v183, 0xffff0000, v176
    v_lshlrev_b32 v184, 16, v178
    v_and_b32 v185, 0xffff0000, v179
    v_add_f32 v180, v180, v182
    v_add_f32 v183, v183, v185
    v_add_f32 v186, v180, v181
    v_sub_f32 v188, v180, v181
    v_add_f32 v187, v183, v184
    v_sub_f32 v189, v183, v184
    v_cvt_pk_bf16_f32 v197, v186, v187
    v_cvt_pk_bf16_f32 v201, v188, v189
L_wp_4:
    s_cmp_eq_u32 s43, 1
    s_cbranch_scc1 L_s1
    s_branch L_sdone
L_semb:
    s_waitcnt vmcnt(0) lgkmcnt(0)
    s_bitcmp1_b32 s44, 0
    s_cbranch_scc1 L_sdone
    v_lshlrev_b32 v148, 16, v112
    v_and_b32 v149, 0xffff0000, v112
    v_lshlrev_b32 v150, 16, v113
    v_and_b32 v151, 0xffff0000, v113
    v_lshlrev_b32 v152, 16, v114
    v_and_b32 v153, 0xffff0000, v114
    v_lshlrev_b32 v154, 16, v116
    v_and_b32 v155, 0xffff0000, v116
    v_lshlrev_b32 v156, 16, v117
    v_and_b32 v157, 0xffff0000, v117
    v_lshlrev_b32 v158, 16, v118
    v_and_b32 v159, 0xffff0000, v118
    v_mul_f32 v160, s93, v148
    v_mul_f32 v161, s93, v149
    v_mul_f32 v162, s93, v150
    v_mul_f32 v163, s93, v151
    v_mul_f32 v164, s93, v152
    v_mul_f32 v165, s93, v153
    v_mul_f32 v166, s93, v154
    v_mul_f32 v167, s93, v155
    v_mul_f32 v168, s93, v156
    v_mul_f32 v169, s93, v157
    v_mul_f32 v170, s93, v158
    v_mul_f32 v171, s93, v159
    v_exp_f32 v160, v160
    v_exp_f32 v161, v161
    v_exp_f32 v162, v162
    v_exp_f32 v163, v163
    v_exp_f32 v164, v164
    v_exp_f32 v165, v165
    v_exp_f32 v166, v166
    v_exp_f32 v167, v167
    v_exp_f32 v168, v168
    v_exp_f32 v169, v169
    v_exp_f32 v170, v170
    v_exp_f32 v171, v171
    v_add_f32 v160, 1.0, v160
    v_add_f32 v161, 1.0, v161
    v_add_f32 v162, 1.0, v162
    v_add_f32 v163, 1.0, v163
    v_add_f32 v164, 1.0, v164
    v_add_f32 v165, 1.0, v165
    v_add_f32 v166, 1.0, v166
    v_add_f32 v167, 1.0, v167
    v_add_f32 v168, 1.0, v168
    v_add_f32 v169, 1.0, v169
    v_add_f32 v170, 1.0, v170
    v_add_f32 v171, 1.0, v171
    v_rcp_f32 v160, v160
    v_rcp_f32 v161, v161
    v_rcp_f32 v162, v162
    v_rcp_f32 v163, v163
    v_rcp_f32 v164, v164
    v_rcp_f32 v165, v165
    v_rcp_f32 v166, v166
    v_rcp_f32 v167, v167
    v_rcp_f32 v168, v168
    v_rcp_f32 v169, v169
    v_rcp_f32 v170, v170
    v_rcp_f32 v171, v171
    v_mul_f32 v148, v148, v160
    v_mul_f32 v149, v149, v161
    v_mul_f32 v150, v150, v162
    v_mul_f32 v151, v151, v163
    v_mul_f32 v152, v152, v164
    v_mul_f32 v153, v153, v165
    v_mul_f32 v154, v154, v166
    v_mul_f32 v155, v155, v167
    v_mul_f32 v156, v156, v168
    v_mul_f32 v157, v157, v169
    v_mul_f32 v158, v158, v170
    v_mul_f32 v159, v159, v171
    v_lshlrev_b32 v160, 16, v120
    v_and_b32 v161, 0xffff0000, v120
    v_mul_f32 v172, v160, v148
    v_mul_f32 v180, v160, v154
    v_mul_f32 v173, v161, v148
    v_mul_f32 v181, v161, v154
    v_lshlrev_b32 v160, 16, v121
    v_and_b32 v161, 0xffff0000, v121
    v_mul_f32 v174, v160, v148
    v_mul_f32 v182, v160, v154
    v_mul_f32 v175, v161, v148
    v_mul_f32 v183, v161, v154
    v_lshlrev_b32 v160, 16, v122
    v_and_b32 v161, 0xffff0000, v122
    v_mul_f32 v176, v160, v148
    v_mul_f32 v184, v160, v154
    v_mul_f32 v177, v161, v148
    v_mul_f32 v185, v161, v154
    v_lshlrev_b32 v160, 16, v123
    v_and_b32 v161, 0xffff0000, v123
    v_mul_f32 v178, v160, v148
    v_mul_f32 v186, v160, v154
    v_mul_f32 v179, v161, v148
    v_mul_f32 v187, v161, v154
    v_lshlrev_b32 v160, 16, v124
    v_and_b32 v161, 0xffff0000, v124
    v_fmac_f32 v172, v160, v149
    v_fmac_f32 v180, v160, v155
    v_fmac_f32 v173, v161, v149
    v_fmac_f32 v181, v161, v155
    v_lshlrev_b32 v160, 16, v125
    v_and_b32 v161, 0xffff0000, v125
    v_fmac_f32 v174, v160, v149
    v_fmac_f32 v182, v160, v155
    v_fmac_f32 v175, v161, v149
    v_fmac_f32 v183, v161, v155
    v_lshlrev_b32 v160, 16, v126
    v_and_b32 v161, 0xffff0000, v126
    v_fmac_f32 v176, v160, v149
    v_fmac_f32 v184, v160, v155
    v_fmac_f32 v177, v161, v149
    v_fmac_f32 v185, v161, v155
    v_lshlrev_b32 v160, 16, v127
    v_and_b32 v161, 0xffff0000, v127
    v_fmac_f32 v178, v160, v149
    v_fmac_f32 v186, v160, v155
    v_fmac_f32 v179, v161, v149
    v_fmac_f32 v187, v161, v155
    v_lshlrev_b32 v160, 16, v128
    v_and_b32 v161, 0xffff0000, v128
    v_fmac_f32 v172, v160, v150
    v_fmac_f32 v180, v160, v156
    v_fmac_f32 v173, v161, v150
    v_fmac_f32 v181, v161, v156
    v_lshlrev_b32 v160, 16, v129
    v_and_b32 v161, 0xffff0000, v129
    v_fmac_f32 v174, v160, v150
    v_fmac_f32 v182, v160, v156
    v_fmac_f32 v175, v161, v150
    v_fmac_f32 v183, v161, v156
    v_lshlrev_b32 v160, 16, v130
    v_and_b32 v161, 0xffff0000, v130
    v_fmac_f32 v176, v160, v150
    v_fmac_f32 v184, v160, v156
    v_fmac_f32 v177, v161, v150
    v_fmac_f32 v185, v161, v156
    v_lshlrev_b32 v160, 16, v131
    v_and_b32 v161, 0xffff0000, v131
    v_fmac_f32 v178, v160, v150
    v_fmac_f32 v186, v160, v156
    v_fmac_f32 v179, v161, v150
    v_fmac_f32 v187, v161, v156
    v_lshlrev_b32 v160, 16, v132
    v_and_b32 v161, 0xffff0000, v132
    v_fmac_f32 v172, v160, v151
    v_fmac_f32 v180, v160, v157
    v_fmac_f32 v173, v161, v151
    v_fmac_f32 v181, v161, v157
    v_lshlrev_b32 v160, 16, v133
    v_and_b32 v161, 0xffff0000, v133
    v_fmac_f32 v174, v160, v151
    v_fmac_f32 v182, v160, v157
    v_fmac_f32 v175, v161, v151
    v_fmac_f32 v183, v161, v157
    v_lshlrev_b32 v160, 16, v134
    v_and_b32 v161, 0xffff0000, v134
    v_fmac_f32 v176, v160, v151
    v_fmac_f32 v184, v160, v157
    v_fmac_f32 v177, v161, v151
    v_fmac_f32 v185, v161, v157
    v_lshlrev_b32 v160, 16, v135
    v_and_b32 v161, 0xffff0000, v135
    v_fmac_f32 v178, v160, v151
    v_fmac_f32 v186, v160, v157
    v_fmac_f32 v179, v161, v151
    v_fmac_f32 v187, v161, v157
    v_lshlrev_b32 v160, 16, v136
    v_and_b32 v161, 0xffff0000, v136
    v_fmac_f32 v172, v160, v152
    v_fmac_f32 v180, v160, v158
    v_fmac_f32 v173, v161, v152
    v_fmac_f32 v181, v161, v158
    v_lshlrev_b32 v160, 16, v137
    v_and_b32 v161, 0xffff0000, v137
    v_fmac_f32 v174, v160, v152
    v_fmac_f32 v182, v160, v158
    v_fmac_f32 v175, v161, v152
    v_fmac_f32 v183, v161, v158
    v_lshlrev_b32 v160, 16, v138
    v_and_b32 v161, 0xffff0000, v138
    v_fmac_f32 v176, v160, v152
    v_fmac_f32 v184, v160, v158
    v_fmac_f32 v177, v161, v152
    v_fmac_f32 v185, v161, v158
    v_lshlrev_b32 v160, 16, v139
    v_and_b32 v161, 0xffff0000, v139
    v_fmac_f32 v178, v160, v152
    v_fmac_f32 v186, v160, v158
    v_fmac_f32 v179, v161, v152
    v_fmac_f32 v187, v161, v158
    v_lshlrev_b32 v160, 16, v140
    v_and_b32 v161, 0xffff0000, v140
    v_fmac_f32 v172, v160, v153
    v_fmac_f32 v180, v160, v159
    v_fmac_f32 v173, v161, v153
    v_fmac_f32 v181, v161, v159
    v_lshlrev_b32 v160, 16, v141
    v_and_b32 v161, 0xffff0000, v141
    v_fmac_f32 v174, v160, v153
    v_fmac_f32 v182, v160, v159
    v_fmac_f32 v175, v161, v153
    v_fmac_f32 v183, v161, v159
    v_lshlrev_b32 v160, 16, v142
    v_and_b32 v161, 0xffff0000, v142
    v_fmac_f32 v176, v160, v153
    v_fmac_f32 v184, v160, v159
    v_fmac_f32 v177, v161, v153
    v_fmac_f32 v185, v161, v159
    v_lshlrev_b32 v160, 16, v143
    v_and_b32 v161, 0xffff0000, v143
    v_fmac_f32 v178, v160, v153
    v_fmac_f32 v186, v160, v159
    v_fmac_f32 v179, v161, v153
    v_fmac_f32 v187, v161, v159
    s_nop 1
    v_permlane32_swap_b32 v172, v180
    v_permlane32_swap_b32 v173, v181
    v_permlane32_swap_b32 v174, v182
    v_permlane32_swap_b32 v175, v183
    v_permlane32_swap_b32 v176, v184
    v_permlane32_swap_b32 v177, v185
    v_permlane32_swap_b32 v178, v186
    v_permlane32_swap_b32 v179, v187
    v_add_f32 v172, v172, v180
    v_add_f32 v173, v173, v181
    v_add_f32 v174, v174, v182
    v_add_f32 v175, v175, v183
    v_add_f32 v176, v176, v184
    v_add_f32 v177, v177, v185
    v_add_f32 v178, v178, v186
    v_add_f32 v179, v179, v187
    s_nop 1
    v_permlane16_swap_b32 v172, v176
    v_permlane16_swap_b32 v173, v177
    v_permlane16_swap_b32 v174, v178
    v_permlane16_swap_b32 v175, v179
    v_add_f32 v172, v172, v176
    v_add_f32 v173, v173, v177
    v_add_f32 v174, v174, v178
    v_add_f32 v175, v175, v179
    s_nop 1
    v_add_f32_dpp v172, v172, v172 row_ror:8 row_mask:0xf bank_mask:0xf
    v_add_f32_dpp v173, v173, v173 row_ror:8 row_mask:0xf bank_mask:0xf
    v_add_f32_dpp v174, v174, v174 row_ror:8 row_mask:0xf bank_mask:0xf
    v_add_f32_dpp v175, v175, v175 row_ror:8 row_mask:0xf bank_mask:0xf
    s_add_u32 s12, s86, 0x2040000
    s_addc_u32 s13, s87, 0
    s_mov_b32 s14, 0x10000
    s_mov_b32 s15, 0x20000
    v_lshrrev_b32 v10, 5, v2
    v_lshlrev_b32 v10, 11, v10
    v_and_b32 v11, 7, v2
    v_lshl_add_u32 v10, v11, 5, v10
    v_and_b32 v11, 16, v2
    v_add_u32 v10, v10, v11
    s_lshl_b32 s3, s49, 12
    s_lshl_b32 s4, s40, 8
    s_add_u32 s3, s3, s4
    buffer_store_dwordx4 v[172:175], v10, s[12:15], s3 offen sc0 sc1
    s_branch L_sdone
L_s1:
    s_waitcnt vmcnt(0)
    s_mov_b32 s3, 0x7fff7fff
    v_and_b32 v112, s3, v112
    v_and_b32 v113, s3, v113
    v_and_b32 v114, s3, v114
    v_and_b32 v115, s3, v115
    v_pk_max_u16 v112, v112, v113
    v_pk_max_u16 v114, v114, v115
    v_pk_max_u16 v112, v112, v114
    v_lshrrev_b32 v113, 16, v112
    v_and_b32 v112, 0xffff, v112
    v_max_u32 v112, v112, v113
    v_and_b32 v116, s3, v116
    v_and_b32 v117, s3, v117
    v_and_b32 v118, s3, v118
    v_and_b32 v119, s3, v119
    v_pk_max_u16 v116, v116, v117
    v_pk_max_u16 v118, v118, v119
    v_pk_max_u16 v116, v116, v118
    v_lshrrev_b32 v117, 16, v116
    v_and_b32 v116, 0xffff, v116
    v_max_u32 v116, v116, v117
    v_and_b32 v120, s3, v120
    v_and_b32 v121, s3, v121
    v_and_b32 v122, s3, v122
    v_and_b32 v123, s3, v123
    v_pk_max_u16 v120, v120, v121
    v_pk_max_u16 v122, v122, v123
    v_pk_max_u16 v120, v120, v122
    v_lshrrev_b32 v121, 16, v120
    v_and_b32 v120, 0xffff, v120
    v_max_u32 v120, v120, v121
    v_and_b32 v124, s3, v124
    v_and_b32 v125, s3, v125
    v_and_b32 v126, s3, v126
    v_and_b32 v127, s3, v127
    v_pk_max_u16 v124, v124, v125
    v_pk_max_u16 v126, v126, v127
    v_pk_max_u16 v124, v124, v126
    v_lshrrev_b32 v125, 16, v124
    v_and_b32 v124, 0xffff, v124
    v_max_u32 v124, v124, v125
    s_nop 1
    v_max_u32_dpp v112, v112, v112 quad_perm:[1,0,3,2] row_mask:0xf bank_mask:0xf
    v_max_u32_dpp v116, v116, v116 quad_perm:[1,0,3,2] row_mask:0xf bank_mask:0xf
    v_max_u32_dpp v120, v120, v120 quad_perm:[1,0,3,2] row_mask:0xf bank_mask:0xf
    v_max_u32_dpp v124, v124, v124 quad_perm:[1,0,3,2] row_mask:0xf bank_mask:0xf
    v_max_u32_dpp v112, v112, v112 quad_perm:[2,3,0,1] row_mask:0xf bank_mask:0xf
    v_max_u32_dpp v116, v116, v116 quad_perm:[2,3,0,1] row_mask:0xf bank_mask:0xf
    v_max_u32_dpp v120, v120, v120 quad_perm:[2,3,0,1] row_mask:0xf bank_mask:0xf
    v_max_u32_dpp v124, v124, v124 quad_perm:[2,3,0,1] row_mask:0xf bank_mask:0xf
    v_max_u32_dpp v112, v112, v112 row_half_mirror row_mask:0xf bank_mask:0xf
    v_max_u32_dpp v116, v116, v116 row_half_mirror row_mask:0xf bank_mask:0xf
    v_max_u32_dpp v120, v120, v120 row_half_mirror row_mask:0xf bank_mask:0xf
    v_max_u32_dpp v124, v124, v124 row_half_mirror row_mask:0xf bank_mask:0xf
    v_max_u32_dpp v112, v112, v112 row_mirror row_mask:0xf bank_mask:0xf
    v_max_u32_dpp v116, v116, v116 row_mirror row_mask:0xf bank_mask:0xf
    v_max_u32_dpp v120, v120, v120 row_mirror row_mask:0xf bank_mask:0xf
    v_max_u32_dpp v124, v124, v124 row_mirror row_mask:0xf bank_mask:0xf
    v_max_u32_dpp v112, v112, v112 row_bcast:15 row_mask:0xa bank_mask:0xf
    v_max_u32_dpp v116, v116, v116 row_bcast:15 row_mask:0xa bank_mask:0xf
    v_max_u32_dpp v120, v120, v120 row_bcast:15 row_mask:0xa bank_mask:0xf
    v_max_u32_dpp v124, v124, v124 row_bcast:15 row_mask:0xa bank_mask:0xf
    v_max_u32_dpp v112, v112, v112 row_bcast:31 row_mask:0xc bank_mask:0xf
    v_max_u32_dpp v116, v116, v116 row_bcast:31 row_mask:0xc bank_mask:0xf
    v_max_u32_dpp v120, v120, v120 row_bcast:31 row_mask:0xc bank_mask:0xf
    v_max_u32_dpp v124, v124, v124 row_bcast:31 row_mask:0xc bank_mask:0xf
    v_lshrrev_b32 v112, 7, v112
    v_lshrrev_b32 v116, 7, v116
    v_add_u32 v112, 10, v112
    v_max_u32 v112, v112, v116
    v_max_u32 v112, 14, v112
    v_min_u32 v112, 0x10a, v112
    v_subrev_u32 v112, 13, v112
    v_lshlrev_b32 v128, 23, v112
    v_lshrrev_b32 v120, 7, v120
    v_lshrrev_b32 v124, 7, v124
    v_add_u32 v120, 10, v120
    v_max_u32 v120, v120, v124
    v_max_u32 v120, 14, v120
    v_min_u32 v120, 0x10a, v120
    v_subrev_u32 v120, 13, v120
    v_lshlrev_b32 v129, 23, v120
    v_mov_b32 v12, 133384
    s_mov_b32 exec_lo, 0
    s_mov_b32 exec_hi, 0x80000000
    ds_write_b64 v12, v[128:129]
    s_mov_b64 exec, -1
    s_waitcnt lgkmcnt(0)
    s_branch L_sdone
L_s0:
    s_mov_b32 s5, 0
L_nonce:
    s_waitcnt vmcnt(0)
    v_readfirstlane_b32 s88, v112
    s_nop 3
    s_cmp_lg_u32 s88, 0
    s_cbranch_scc1 L_nonced
    s_add_u32 s5, s5, 1
    s_cmp_lt_u32 s5, 0x80000
    s_cbranch_scc0 L_nonced
    s_sleep 4
    s_mov_b32 s32, s84
    s_mov_b32 s33, s85
    s_mov_b32 s34, 0x100
    s_mov_b32 s35, 0x20000
    buffer_load_dword v112, v14, s[32:35], 0 offen sc0 sc1
    s_branch L_nonce
L_nonced:
    v_mov_b32 v12, 133392
    v_mov_b32 v13, s88
    ds_write_b32 v12, v13
    s_lshl_b32 s51, s41, 2
    s_lshr_b32 s3, s40, 1
    s_add_u32 s51, s51, s3
    s_lshl_b32 s51, s51, 12
    s_add_u32 s51, s51, 0
    s_and_b32 s50, s40, 1
    s_lshl_b32 s50, s50, 4
    s_add_u32 s50, s50, s42
    s_lshl_b32 s50, s50, 7
    s_add_u32 s50, s50, s51
    v_lshlrev_b32 v12, 4, v8
    v_add_u32 v12, 133120, v12
    ds_read_b128 v[24:27], v12
    v_and_b32 v13, 31, v2
    v_lshlrev_b32 v13, 7, v13
    v_mov_b32 v29, s88
    v_mov_b32 v31, s88
    v_mov_b32 v14, 0
    s_waitcnt lgkmcnt(0)
    v_add_f32 v24, v24, v26
    v_add_f32 v25, v25, v27
    s_nop 1
    v_add_f32_dpp v24, v24, v24 quad_perm:[1,0,3,2] row_mask:0xf bank_mask:0xf
    v_add_f32_dpp v25, v25, v25 quad_perm:[1,0,3,2] row_mask:0xf bank_mask:0xf
    s_nop 0
    v_add_f32_dpp v24, v24, v24 quad_perm:[2,3,0,1] row_mask:0xf bank_mask:0xf
    v_add_f32_dpp v25, v25, v25 quad_perm:[2,3,0,1] row_mask:0xf bank_mask:0xf
    s_nop 0
    v_add_f32_dpp v24, v24, v24 row_half_mirror row_mask:0xf bank_mask:0xf
    v_add_f32_dpp v25, v25, v25 row_half_mirror row_mask:0xf bank_mask:0xf
    s_nop 0
    v_add_f32_dpp v24, v24, v24 row_mirror row_mask:0xf bank_mask:0xf
    v_add_f32_dpp v25, v25, v25 row_mirror row_mask:0xf bank_mask:0xf
    s_nop 0
    v_mul_f32 v26, 0x38800000, v24
    v_add_f32 v28, v20, v26
    v_fma_f32 v30, -v24, v26, v25
    v_max_f32 v30, 0, v30
    s_mov_b64 exec, 1
    buffer_store_dwordx4 v[28:31], v14, s[20:23], s50 offen sc0 sc1
    s_mov_b64 exec, -1
    s_mul_i32 s3, s45, 16896
    s_lshl_b32 s4, s46, 7
    s_add_u32 s3, s3, s4
    s_add_u32 s3, s3, 20480
    v_mul_u32_u24 v10, 4224, v3
    v_lshl_add_u32 v10, v4, 3, v10
    v_add_u32 v10, s3, v10
    ds_write_b64 v10, v[48:49] offset:0
    ds_write_b64 v10, v[50:51] offset:512
    ds_write_b64 v10, v[52:53] offset:1024
    ds_write_b64 v10, v[54:55] offset:1536
    ds_write_b64 v10, v[56:57] offset:2048
    ds_write_b64 v10, v[58:59] offset:2560
    ds_write_b64 v10, v[60:61] offset:3072
    ds_write_b64 v10, v[62:63] offset:3584
    s_sleep 8
    s_mov_b32 s5, 0
L_poll_5:
    buffer_load_dwordx4 v[32:35], v13, s[20:23], s51 offen sc0 sc1
    s_waitcnt vmcnt(0)
    v_cmp_ne_u32 vcc, s88, v33
    v_cmp_ne_u32 s[6:7], s88, v35
    s_or_b64 vcc, vcc, s[6:7]
    s_cbranch_scc0 L_polld_6
    s_add_u32 s5, s5, 1
    s_cmp_lt_u32 s5, 0x80000
    s_cbranch_scc0 L_polld_6
    s_sleep 1
    s_branch L_poll_5
L_polld_6:
    v_readfirstlane_b32 s6, v32
    s_nop 1
    v_subrev_f32 v36, s6, v32
    v_mul_f32 v37, v36, v36
    s_nop 1
    v_add_f32_dpp v36, v36, v36 quad_perm:[1,0,3,2] row_mask:0xf bank_mask:0xf
    v_add_f32_dpp v37, v37, v37 quad_perm:[1,0,3,2] row_mask:0xf bank_mask:0xf
    v_add_f32_dpp v34, v34, v34 quad_perm:[1,0,3,2] row_mask:0xf bank_mask:0xf
    v_add_f32_dpp v36, v36, v36 quad_perm:[2,3,0,1] row_mask:0xf bank_mask:0xf
    v_add_f32_dpp v37, v37, v37 quad_perm:[2,3,0,1] row_mask:0xf bank_mask:0xf
    v_add_f32_dpp v34, v34, v34 quad_perm:[2,3,0,1] row_mask:0xf bank_mask:0xf
    v_add_f32_dpp v36, v36, v36 row_half_mirror row_mask:0xf bank_mask:0xf
    v_add_f32_dpp v37, v37, v37 row_half_mirror row_mask:0xf bank_mask:0xf
    v_add_f32_dpp v34, v34, v34 row_half_mirror row_mask:0xf bank_mask:0xf
    v_add_f32_dpp v36, v36, v36 row_mirror row_mask:0xf bank_mask:0xf
    v_add_f32_dpp v37, v37, v37 row_mirror row_mask:0xf bank_mask:0xf
    v_add_f32_dpp v34, v34, v34 row_mirror row_mask:0xf bank_mask:0xf
    v_add_f32_dpp v36, v36, v36 row_bcast:15 row_mask:0xa bank_mask:0xf
    v_add_f32_dpp v37, v37, v37 row_bcast:15 row_mask:0xa bank_mask:0xf
    v_add_f32_dpp v34, v34, v34 row_bcast:15 row_mask:0xa bank_mask:0xf
    v_mul_f32 v41, 0x3d000000, v36
    v_fma_f32 v42, -v36, v41, v37
    v_max_f32 v42, 0, v42
    v_fmac_f32 v34, 0x46800000, v42
    v_mov_b32 v43, 0x3727c5ac
    v_fmac_f32 v43, 0x36000000, v34
    v_add_f32 v42, s6, v41
    v_rsq_f32 v43, v43
    v_mov_b32 v12, 133376
    s_mov_b32 exec_lo, 0x80000000
    s_mov_b32 exec_hi, 0
    ds_write_b64 v12, v[42:43]
    s_mov_b64 exec, -1
    s_waitcnt lgkmcnt(0)
L_sdone:
    s_barrier
    v_mov_b32 v12, 133376
    ds_read_b128 v[16:19], v12
    ds_read_b32 v22, v12 offset:16
    s_cmp_eq_u32 s46, 0
    s_cbranch_scc1 L_nop1
    s_add_u32 s12, s86, 0x1000000
    s_addc_u32 s13, s87, 0
    s_mov_b32 s14, 0x600000
    s_mov_b32 s15, 0x20000
    buffer_store_dwordx4 v[190:193], v6, s[12:15], s39 offen sc0 sc1
    s_add_u32 s39, s39, 196608
    buffer_store_dwordx4 v[194:197], v6, s[12:15], s39 offen sc0 sc1
    s_add_u32 s39, s39, 196608
    buffer_store_dwordx4 v[198:201], v6, s[12:15], s39 offen sc0 sc1
    s_add_u32 s39, s39, 196608
    buffer_store_dwordx4 v[202:205], v6, s[12:15], s39 offen sc0 sc1
    s_add_u32 s39, s39, 196608
    s_nop 1
L_nop1:
    s_mov_b32 s8, s86
    s_mov_b32 s9, s87
    s_mov_b32 s10, 0x800000
    s_mov_b32 s11, 0x20000
    v_bfe_u32 v10, v4, 2, 1
    v_lshlrev_b32 v10, 1, v10
    v_xor_b32 v10, v10, v3
    v_lshlrev_b32 v10, 4, v10
    v_lshl_add_u32 v10, v4, 6, v10
    s_lshl_b32 s47, s41, 4
    s_lshl_b32 s3, s40, 1
    s_add_u32 s47, s47, s3
    s_add_u32 s47, s47, s45
    s_lshl_b32 s47, s47, 18
    s_lshl_b32 s3, s42, 14
    s_add_u32 s47, s47, s3
    s_lshl_b32 s3, s46, 12
    s_add_u32 s47, s47, s3
    v_lshlrev_b32 v24, 16, v64
    v_and_b32 v25, 0xffff0000, v64
    v_lshlrev_b32 v32, 16, v68
    v_and_b32 v33, 0xffff0000, v68
    v_lshlrev_b32 v26, 16, v65
    v_and_b32 v27, 0xffff0000, v65
    v_lshlrev_b32 v34, 16, v69
    v_and_b32 v35, 0xffff0000, v69
    v_lshlrev_b32 v28, 16, v66
    v_and_b32 v29, 0xffff0000, v66
    v_lshlrev_b32 v36, 16, v70
    v_and_b32 v37, 0xffff0000, v70
    v_lshlrev_b32 v30, 16, v67
    v_and_b32 v31, 0xffff0000, v67
    v_lshlrev_b32 v38, 16, v71
    v_and_b32 v39, 0xffff0000, v71
    s_waitcnt lgkmcnt(0)
    v_sub_f32 v16, v16, v20
    v_pk_mul_f32 v[24:25], v[24:25], v[16:17] op_sel:[0,1]
    v_pk_mul_f32 v[26:27], v[26:27], v[16:17] op_sel:[0,1]
    v_pk_mul_f32 v[28:29], v[28:29], v[16:17] op_sel:[0,1]
    v_pk_mul_f32 v[30:31], v[30:31], v[16:17] op_sel:[0,1]
    v_pk_fma_f32 v[32:33], v[24:25], v[16:17], v[32:33] op_sel_hi:[1,0,1] neg_lo:[1,0,0] neg_hi:[1,0,0]
    v_pk_fma_f32 v[34:35], v[26:27], v[16:17], v[34:35] op_sel_hi:[1,0,1] neg_lo:[1,0,0] neg_hi:[1,0,0]
    v_pk_fma_f32 v[36:37], v[28:29], v[16:17], v[36:37] op_sel_hi:[1,0,1] neg_lo:[1,0,0] neg_hi:[1,0,0]
    v_pk_fma_f32 v[38:39], v[30:31], v[16:17], v[38:39] op_sel_hi:[1,0,1] neg_lo:[1,0,0] neg_hi:[1,0,0]
    v_readfirstlane_b32 s90, v18
    v_readfirstlane_b32 s92, v19
    v_readfirstlane_b32 s88, v22
    v_pk_fma_f32 v[72:73], v[72:73], v[24:25], v[32:33] op_sel_hi:[1,0,0]
    v_pk_fma_f32 v[76:77], v[76:77], v[24:25], v[32:33] op_sel:[0,1,1]
    v_pk_fma_f32 v[80:81], v[80:81], v[26:27], v[34:35] op_sel_hi:[1,0,0]
    v_pk_fma_f32 v[84:85], v[84:85], v[26:27], v[34:35] op_sel:[0,1,1]
    v_pk_fma_f32 v[88:89], v[88:89], v[28:29], v[36:37] op_sel_hi:[1,0,0]
    v_pk_fma_f32 v[92:93], v[92:93], v[28:29], v[36:37] op_sel:[0,1,1]
    v_pk_fma_f32 v[96:97], v[96:97], v[30:31], v[38:39] op_sel_hi:[1,0,0]
    v_pk_fma_f32 v[100:101], v[100:101], v[30:31], v[38:39] op_sel:[0,1,1]
    v_pk_mul_f32 v[40:41], v[72:73], s[92:93] op_sel:[0,1]
    v_pk_mul_f32 v[42:43], v[76:77], s[92:93] op_sel:[0,1]
    v_pk_mul_f32 v[44:45], v[80:81], s[92:93] op_sel:[0,1]
    v_pk_mul_f32 v[46:47], v[84:85], s[92:93] op_sel:[0,1]
    v_pk_mul_f32 v[48:49], v[88:89], s[92:93] op_sel:[0,1]
    v_pk_mul_f32 v[50:51], v[92:93], s[92:93] op_sel:[0,1]
    v_pk_mul_f32 v[52:53], v[96:97], s[92:93] op_sel:[0,1]
    v_pk_mul_f32 v[54:55], v[100:101], s[92:93] op_sel:[0,1]
    v_exp_f32 v40, v40
    v_exp_f32 v41, v41
    v_exp_f32 v42, v42
    v_exp_f32 v43, v43
    v_exp_f32 v44, v44
    v_exp_f32 v45, v45
    v_exp_f32 v46, v46
    v_exp_f32 v47, v47
    v_exp_f32 v48, v48
    v_exp_f32 v49, v49
    v_exp_f32 v50, v50
    v_exp_f32 v51, v51
    v_exp_f32 v52, v52
    v_exp_f32 v53, v53
    v_exp_f32 v54, v54
    v_exp_f32 v55, v55
    v_pk_fma_f32 v[40:41], v[40:41], s[90:91], s[90:91] op_sel_hi:[1,0,0]
    v_pk_fma_f32 v[42:43], v[42:43], s[90:91], s[90:91] op_sel_hi:[1,0,0]
    v_pk_fma_f32 v[44:45], v[44:45], s[90:91], s[90:91] op_sel_hi:[1,0,0]
    v_pk_fma_f32 v[46:47], v[46:47], s[90:91], s[90:91] op_sel_hi:[1,0,0]
    v_pk_fma_f32 v[48:49], v[48:49], s[90:91], s[90:91] op_sel_hi:[1,0,0]
    v_pk_fma_f32 v[50:51], v[50:51], s[90:91], s[90:91] op_sel_hi:[1,0,0]
    v_pk_fma_f32 v[52:53], v[52:53], s[90:91], s[90:91] op_sel_hi:[1,0,0]
    v_pk_fma_f32 v[54:55], v[54:55], s[90:91], s[90:91] op_sel_hi:[1,0,0]
    v_rcp_f32 v40, v40
    v_rcp_f32 v41, v41
    v_rcp_f32 v42, v42
    v_rcp_f32 v43, v43
    v_rcp_f32 v44, v44
    v_rcp_f32 v45, v45
    v_rcp_f32 v46, v46
    v_rcp_f32 v47, v47
    v_rcp_f32 v48, v48
    v_rcp_f32 v49, v49
    v_rcp_f32 v50, v50
    v_rcp_f32 v51, v51
    v_rcp_f32 v52, v52
    v_rcp_f32 v53, v53
    v_rcp_f32 v54, v54
    v_rcp_f32 v55, v55
    v_pk_mul_f32 v[72:73], v[72:73], v[40:41]
    v_pk_mul_f32 v[76:77], v[76:77], v[42:43]
    v_pk_mul_f32 v[80:81], v[80:81], v[44:45]
    v_pk_mul_f32 v[84:85], v[84:85], v[46:47]
    v_pk_mul_f32 v[88:89], v[88:89], v[48:49]
    v_pk_mul_f32 v[92:93], v[92:93], v[50:51]
    v_pk_mul_f32 v[96:97], v[96:97], v[52:53]
    v_pk_mul_f32 v[100:101], v[100:101], v[54:55]
    v_cvt_pk_f16_f32 v56, v72, v76
    v_cvt_pk_f16_f32 v57, v80, v84
    v_cvt_pk_f16_f32 v58, v88, v92
    v_cvt_pk_f16_f32 v59, v96, v100
    buffer_store_dwordx4 v[56:59], v10, s[8:11], s47 offen offset:0 sc0 sc1
    v_cvt_pk_f16_f32 v60, v73, v77
    v_cvt_pk_f16_f32 v61, v81, v85
    v_cvt_pk_f16_f32 v62, v89, v93
    v_cvt_pk_f16_f32 v63, v97, v101
    buffer_store_dwordx4 v[60:63], v10, s[8:11], s47 offen offset:1024 sc0 sc1
    v_pk_fma_f32 v[74:75], v[74:75], v[24:25], v[32:33] op_sel_hi:[1,0,0]
    v_pk_fma_f32 v[78:79], v[78:79], v[24:25], v[32:33] op_sel:[0,1,1]
    v_pk_fma_f32 v[82:83], v[82:83], v[26:27], v[34:35] op_sel_hi:[1,0,0]
    v_pk_fma_f32 v[86:87], v[86:87], v[26:27], v[34:35] op_sel:[0,1,1]
    v_pk_fma_f32 v[90:91], v[90:91], v[28:29], v[36:37] op_sel_hi:[1,0,0]
    v_pk_fma_f32 v[94:95], v[94:95], v[28:29], v[36:37] op_sel:[0,1,1]
    v_pk_fma_f32 v[98:99], v[98:99], v[30:31], v[38:39] op_sel_hi:[1,0,0]
    v_pk_fma_f32 v[102:103], v[102:103], v[30:31], v[38:39] op_sel:[0,1,1]
    v_pk_mul_f32 v[40:41], v[74:75], s[92:93] op_sel:[0,1]
    v_pk_mul_f32 v[42:43], v[78:79], s[92:93] op_sel:[0,1]
    v_pk_mul_f32 v[44:45], v[82:83], s[92:93] op_sel:[0,1]
    v_pk_mul_f32 v[46:47], v[86:87], s[92:93] op_sel:[0,1]
    v_pk_mul_f32 v[48:49], v[90:91], s[92:93] op_sel:[0,1]
    v_pk_mul_f32 v[50:51], v[94:95], s[92:93] op_sel:[0,1]
    v_pk_mul_f32 v[52:53], v[98:99], s[92:93] op_sel:[0,1]
    v_pk_mul_f32 v[54:55], v[102:103], s[92:93] op_sel:[0,1]
    v_exp_f32 v40, v40
    v_exp_f32 v41, v41
    v_exp_f32 v42, v42
    v_exp_f32 v43, v43
    v_exp_f32 v44, v44
    v_exp_f32 v45, v45
    v_exp_f32 v46, v46
    v_exp_f32 v47, v47
    v_exp_f32 v48, v48
    v_exp_f32 v49, v49
    v_exp_f32 v50, v50
    v_exp_f32 v51, v51
    v_exp_f32 v52, v52
    v_exp_f32 v53, v53
    v_exp_f32 v54, v54
    v_exp_f32 v55, v55
    v_pk_fma_f32 v[40:41], v[40:41], s[90:91], s[90:91] op_sel_hi:[1,0,0]
    v_pk_fma_f32 v[42:43], v[42:43], s[90:91], s[90:91] op_sel_hi:[1,0,0]
    v_pk_fma_f32 v[44:45], v[44:45], s[90:91], s[90:91] op_sel_hi:[1,0,0]
    v_pk_fma_f32 v[46:47], v[46:47], s[90:91], s[90:91] op_sel_hi:[1,0,0]
    v_pk_fma_f32 v[48:49], v[48:49], s[90:91], s[90:91] op_sel_hi:[1,0,0]
    v_pk_fma_f32 v[50:51], v[50:51], s[90:91], s[90:91] op_sel_hi:[1,0,0]
    v_pk_fma_f32 v[52:53], v[52:53], s[90:91], s[90:91] op_sel_hi:[1,0,0]
    v_pk_fma_f32 v[54:55], v[54:55], s[90:91], s[90:91] op_sel_hi:[1,0,0]
    v_rcp_f32 v40, v40
    v_rcp_f32 v41, v41
    v_rcp_f32 v42, v42
    v_rcp_f32 v43, v43
    v_rcp_f32 v44, v44
    v_rcp_f32 v45, v45
    v_rcp_f32 v46, v46
    v_rcp_f32 v47, v47
    v_rcp_f32 v48, v48
    v_rcp_f32 v49, v49
    v_rcp_f32 v50, v50
    v_rcp_f32 v51, v51
    v_rcp_f32 v52, v52
    v_rcp_f32 v53, v53
    v_rcp_f32 v54, v54
    v_rcp_f32 v55, v55
    v_pk_mul_f32 v[74:75], v[74:75], v[40:41]
    v_pk_mul_f32 v[78:79], v[78:79], v[42:43]
    v_pk_mul_f32 v[82:83], v[82:83], v[44:45]
    v_pk_mul_f32 v[86:87], v[86:87], v[46:47]
    v_pk_mul_f32 v[90:91], v[90:91], v[48:49]
    v_pk_mul_f32 v[94:95], v[94:95], v[50:51]
    v_pk_mul_f32 v[98:99], v[98:99], v[52:53]
    v_pk_mul_f32 v[102:103], v[102:103], v[54:55]
    v_cvt_pk_f16_f32 v64, v74, v78
    v_cvt_pk_f16_f32 v65, v82, v86
    v_cvt_pk_f16_f32 v66, v90, v94
    v_cvt_pk_f16_f32 v67, v98, v102
    buffer_store_dwordx4 v[64:67], v10, s[8:11], s47 offen offset:2048 sc0 sc1
    v_cvt_pk_f16_f32 v68, v75, v79
    v_cvt_pk_f16_f32 v69, v83, v87
    v_cvt_pk_f16_f32 v70, v91, v95
    v_cvt_pk_f16_f32 v71, v99, v103
    buffer_store_dwordx4 v[68:71], v10, s[8:11], s47 offen offset:3072 sc0 sc1
    s_cmp_lt_u32 s43, 4
    s_cbranch_scc1 L_nores
    s_bfe_u32 s3, s43, 0x10001
    s_lshl_b32 s3, s3, 11
    s_and_b32 s4, s43, 1
    s_lshl_b32 s4, s4, 8
    s_add_u32 s3, s3, s4
    s_add_u32 s3, s3, 20480
    v_mul_u32_u24 v10, 4224, v9
    v_lshl_add_u32 v10, v8, 3, v10
    v_add_u32 v10, s3, v10
    v_add_u32 v11, 16896, v10
    ds_read2_b64 v[208:211], v11 offset0:0 offset1:16
    ds_read2_b64 v[224:227], v10 offset0:0 offset1:16
    ds_read2_b64 v[212:215], v11 offset0:64 offset1:80
    ds_read2_b64 v[228:231], v10 offset0:64 offset1:80
    ds_read2_b64 v[216:219], v11 offset0:128 offset1:144
    ds_read2_b64 v[232:235], v10 offset0:128 offset1:144
    ds_read2_b64 v[220:223], v11 offset0:192 offset1:208
    ds_read2_b64 v[236:239], v10 offset0:192 offset1:208
    s_waitcnt lgkmcnt(0)
L_nores:
    v_lshrrev_b32 v12, 3, v2
    v_min_u32 v12, 2, v12
    v_add_u32 v12, s42, v12
    v_max_u32 v12, 1, v12
    v_min_u32 v12, 16, v12
    s_lshl_b32 s3, s41, 4
    s_sub_u32 s3, s3, 1
    v_add_u32 v12, s3, v12
    v_and_b32 v13, 7, v2
    v_lshl_add_u32 v12, v12, 3, v13
    v_subrev_u32 v13, 32, v2
    v_lshlrev_b32 v13, 3, v13
    v_add_u32 v13, s40, v13
    v_cmp_gt_u32 vcc, 32, v2
    s_lshl_b32 s50, s44, 3
    s_add_u32 s50, s50, s40
    v_cndmask_b32 v12, v13, v12, vcc
    v_lshlrev_b32 v12, 7, v12
    v_add_u32 v23, 32768, v12
    s_lshl_b32 s50, s50, 7
    s_add_u32 s50, s50, 32768
L_conv:
    v_mov_b32 v22, s88
    v_mov_b32 v14, 0
    s_cmp_lg_u32 s43, 4
    s_waitcnt vmcnt(0)
    s_barrier
    s_cbranch_scc1 L_noflag
    s_mov_b64 exec, 1
    buffer_store_dword v22, v14, s[20:23], s50 offen sc0 sc1
    s_mov_b64 exec, -1
L_noflag:
    s_sub_u32 s91, s90, 0x800000
    s_lshl_b32 s3, s89, 23
    s_cmp_ge_u32 s43, 4
    s_cbranch_scc1 L_prod
    s_lshl_b32 s4, s40, 2
    s_add_u32 s4, s4, s43
    s_mul_i32 s4, s4, 196608
    s_add_u32 s3, s3, s4
    s_add_u32 s3, s3, 0x1000000
    s_add_u32 s16, s86, s3
    s_addc_u32 s17, s87, 0
    s_mov_b32 s18, 0x30000
    s_mov_b32 s19, 0x20000
    s_mov_b32 s52, 0
    s_mul_i32 s3, s43, 33280
    v_add_u32 v11, 15, v8
    v_bfe_u32 v12, v11, 2, 1
    v_lshlrev_b32 v12, 1, v12
    v_xor_b32 v12, v12, v9
    v_lshlrev_b32 v12, 4, v12
    v_lshl_add_u32 v12, v8, 6, v12
    v_add_u32 v3, s3, v12
    v_add_u32 v11, 16, v8
    v_bfe_u32 v12, v11, 2, 1
    v_lshlrev_b32 v12, 1, v12
    v_xor_b32 v12, v12, v9
    v_lshlrev_b32 v12, 4, v12
    v_lshl_add_u32 v12, v8, 6, v12
    v_add_u32 v4, s3, v12
    v_add_u32 v11, 17, v8
    v_bfe_u32 v12, v11, 2, 1
    v_lshlrev_b32 v12, 1, v12
    v_xor_b32 v12, v12, v9
    v_lshlrev_b32 v12, 4, v12
    v_lshl_add_u32 v12, v8, 6, v12
    v_add_u32 v5, s3, v12
    v_bfe_u32 v11, v2, 2, 3
    v_mul_u32_u24 v11, 4160, v11
    v_and_b32 v12, 3, v2
    v_lshl_add_u32 v11, v12, 4, v11
    v_add_u32 v11, s3, v11
    v_mov_b32 v128, 0
    v_mov_b32 v129, 0
    v_mov_b32 v130, 0
    v_mov_b32 v131, 0
    v_mov_b32 v132, 0
    v_mov_b32 v133, 0
    v_mov_b32 v134, 0
    v_mov_b32 v135, 0
    v_mov_b32 v136, 0
    v_mov_b32 v137, 0
    v_mov_b32 v138, 0
    v_mov_b32 v139, 0
    v_mov_b32 v140, 0
    v_mov_b32 v141, 0
    v_mov_b32 v142, 0
    v_mov_b32 v143, 0
    v_mov_b32 v144, 0
    v_mov_b32 v145, 0
    v_mov_b32 v146, 0
    v_mov_b32 v147, 0
    v_mov_b32 v148, 0
    v_mov_b32 v149, 0
    v_mov_b32 v150, 0
    v_mov_b32 v151, 0
    v_mov_b32 v152, 0
    v_mov_b32 v153, 0
    v_mov_b32 v154, 0
    v_mov_b32 v155, 0
    v_mov_b32 v156, 0
    v_mov_b32 v157, 0
    v_mov_b32 v158, 0
    v_mov_b32 v159, 0
    v_mov_b32 v160, 0
    v_mov_b32 v161, 0
    v_mov_b32 v162, 0
    v_mov_b32 v163, 0
    v_mov_b32 v164, 0
    v_mov_b32 v165, 0
    v_mov_b32 v166, 0
    v_mov_b32 v167, 0
    v_mov_b32 v168, 0
    v_mov_b32 v169, 0
    v_mov_b32 v170, 0
    v_mov_b32 v171, 0
    v_mov_b32 v172, 0
    v_mov_b32 v173, 0
    v_mov_b32 v174, 0
    v_mov_b32 v175, 0
    v_mov_b32 v176, 0
    v_mov_b32 v177, 0
    v_mov_b32 v178, 0
    v_mov_b32 v179, 0
    v_mov_b32 v180, 0
    v_mov_b32 v181, 0
    v_mov_b32 v182, 0
    v_mov_b32 v183, 0
    v_mov_b32 v184, 0
    v_mov_b32 v185, 0
    v_mov_b32 v186, 0
    v_mov_b32 v187, 0
    v_mov_b32 v188, 0
    v_mov_b32 v189, 0
    v_mov_b32 v190, 0
    v_mov_b32 v191, 0
    v_mov_b32 v192, 0
    v_mov_b32 v193, 0
    v_mov_b32 v194, 0
    v_mov_b32 v195, 0
    v_mov_b32 v196, 0
    v_mov_b32 v197, 0
    v_mov_b32 v198, 0
    v_mov_b32 v199, 0
    v_mov_b32 v200, 0
    v_mov_b32 v201, 0
    v_mov_b32 v202, 0
    v_mov_b32 v203, 0
    v_mov_b32 v204, 0
    v_mov_b32 v205, 0
    v_mov_b32 v206, 0
    v_mov_b32 v207, 0
    v_mov_b32 v208, 0
    v_mov_b32 v209, 0
    v_mov_b32 v210, 0
    v_mov_b32 v211, 0
    v_mov_b32 v212, 0
    v_mov_b32 v213, 0
    v_mov_b32 v214, 0
    v_mov_b32 v215, 0
    v_mov_b32 v216, 0
    v_mov_b32 v217, 0
    v_mov_b32 v218, 0
    v_mov_b32 v219, 0
    v_mov_b32 v220, 0
    v_mov_b32 v221, 0
    v_mov_b32 v222, 0
    v_mov_b32 v223, 0
    v_mov_b32 v224, 0
    v_mov_b32 v225, 0
    v_mov_b32 v226, 0
    v_mov_b32 v227, 0
    v_mov_b32 v228, 0
    v_mov_b32 v229, 0
    v_mov_b32 v230, 0
    v_mov_b32 v231, 0
    v_mov_b32 v232, 0
    v_mov_b32 v233, 0
    v_mov_b32 v234, 0
    v_mov_b32 v235, 0
    v_mov_b32 v236, 0
    v_mov_b32 v237, 0
    v_mov_b32 v238, 0
    v_mov_b32 v239, 0
    v_mov_b32 v240, 0
    v_mov_b32 v241, 0
    v_mov_b32 v242, 0
    v_mov_b32 v243, 0
    v_mov_b32 v244, 0
    v_mov_b32 v245, 0
    v_mov_b32 v246, 0
    v_mov_b32 v247, 0
    v_mov_b32 v248, 0
    v_mov_b32 v249, 0
    v_mov_b32 v250, 0
    v_mov_b32 v251, 0
    v_mov_b32 v252, 0
    v_mov_b32 v253, 0
    v_mov_b32 v254, 0
    v_mov_b32 v255, 0
    ds_write_b128 v11, v[128:131] offset:1024
    v_add_u32 v7, s3, v6
    s_waitcnt lgkmcnt(0)
    s_cmp_lg_u32 s89, 0
    s_cbranch_scc1 L_uerly
    s_barrier
L_uerly:
    buffer_load_dwordx4 v[64:67], v6, s[16:19], s52 offen offset:0 sc0 sc1
    buffer_load_dwordx4 v[68:71], v6, s[16:19], s52 offen offset:1024 sc0 sc1
    buffer_load_dwordx4 v[72:75], v6, s[16:19], s52 offen offset:2048 sc0 sc1
    buffer_load_dwordx4 v[76:79], v6, s[16:19], s52 offen offset:3072 sc0 sc1
    s_add_u32 s52, s52, 4096
    buffer_load_dwordx4 v[80:83], v6, s[16:19], s52 offen offset:0 sc0 sc1
    buffer_load_dwordx4 v[84:87], v6, s[16:19], s52 offen offset:1024 sc0 sc1
    buffer_load_dwordx4 v[88:91], v6, s[16:19], s52 offen offset:2048 sc0 sc1
    buffer_load_dwordx4 v[92:95], v6, s[16:19], s52 offen offset:3072 sc0 sc1
    s_add_u32 s52, s52, 4096
    buffer_load_dwordx4 v[96:99], v6, s[16:19], s52 offen offset:0 sc0 sc1
    buffer_load_dwordx4 v[100:103], v6, s[16:19], s52 offen offset:1024 sc0 sc1
    buffer_load_dwordx4 v[104:107], v6, s[16:19], s52 offen offset:2048 sc0 sc1
    buffer_load_dwordx4 v[108:111], v6, s[16:19], s52 offen offset:3072 sc0 sc1
    s_add_u32 s52, s52, 4096
    buffer_load_dwordx4 v[112:115], v6, s[16:19], s52 offen offset:0 sc0 sc1
    s_cmp_eq_u32 s89, 0
    s_cbranch_scc1 L_ulate
    s_barrier
L_ulate:
    s_barrier
    ds_read_b128 v[16:19], v3 offset:1024
    ds_read_b128 v[20:23], v4 offset:0
    ds_read_b128 v[24:27], v4 offset:2112
    ds_read_b128 v[28:31], v4 offset:3136
    ds_read_b128 v[32:35], v4 offset:1088
    ds_read_b128 v[36:39], v5 offset:64
    ds_read_b128 v[40:43], v3 offset:5184
    ds_read_b128 v[44:47], v4 offset:4160
    ds_read_b128 v[48:51], v4 offset:6272
    s_add_u32 s52, s52, 1024
    s_mov_b32 s53, 0
.p2align 6
L_loop:
    s_waitcnt vmcnt(10) lgkmcnt(6)
    v_mfma_f32_16x16x32_bf16 v[128:131], v[64:67], v[16:19], v[128:131]
    ds_read_b128 v[52:55], v4 offset:7296
    v_mfma_f32_16x16x32_bf16 v[128:131], v[68:71], v[20:23], v[128:131]
    ds_read_b128 v[56:59], v4 offset:5248
    v_mfma_f32_16x16x32_bf16 v[128:131], v[72:75], v[24:27], v[128:131]
    ds_read_b128 v[60:63], v5 offset:4224
    s_waitcnt lgkmcnt(6)
    v_mfma_f32_16x16x32_bf16 v[132:135], v[72:75], v[28:31], v[132:135]
    v_mfma_f32_16x16x32_bf16 v[132:135], v[68:71], v[24:27], v[132:135]
    buffer_load_dwordx4 v[116:119], v6, s[16:19], s52 offen offset:0 sc0 sc1
    v_mfma_f32_16x16x32_bf16 v[132:135], v[64:67], v[20:23], v[132:135]
    v_mfma_f32_16x16x32_bf16 v[136:139], v[64:67], v[24:27], v[136:139]
    v_mfma_f32_16x16x32_bf16 v[136:139], v[68:71], v[28:31], v[136:139]
    v_mfma_f32_16x16x32_bf16 v[136:139], v[72:75], v[32:35], v[136:139]
    v_mfma_f32_16x16x32_bf16 v[140:143], v[72:75], v[36:39], v[140:143]
    v_mfma_f32_16x16x32_bf16 v[140:143], v[68:71], v[32:35], v[140:143]
    buffer_load_dwordx4 v[120:123], v6, s[16:19], s52 offen offset:1024 sc0 sc1
    v_mfma_f32_16x16x32_bf16 v[140:143], v[64:67], v[28:31], v[140:143]
    s_waitcnt lgkmcnt(3)
    v_mfma_f32_16x16x32_bf16 v[144:147], v[64:67], v[40:43], v[144:147]
    v_mfma_f32_16x16x32_bf16 v[144:147], v[68:71], v[44:47], v[144:147]
    v_mfma_f32_16x16x32_bf16 v[144:147], v[72:75], v[48:51], v[144:147]
    s_waitcnt lgkmcnt(0)
    v_mfma_f32_16x16x32_bf16 v[148:151], v[72:75], v[52:55], v[148:151]
    v_mfma_f32_16x16x32_bf16 v[148:151], v[68:71], v[48:51], v[148:151]
    buffer_load_dwordx4 v[124:127], v6, s[16:19], s52 offen offset:2048 sc0 sc1
    v_mfma_f32_16x16x32_bf16 v[148:151], v[64:67], v[44:47], v[148:151]
    v_mfma_f32_16x16x32_bf16 v[152:155], v[64:67], v[48:51], v[152:155]
    v_mfma_f32_16x16x32_bf16 v[152:155], v[68:71], v[52:55], v[152:155]
    v_mfma_f32_16x16x32_bf16 v[152:155], v[72:75], v[56:59], v[152:155]
    s_add_u32 s52, s52, 3072
    v_mfma_f32_16x16x32_bf16 v[156:159], v[72:75], v[60:63], v[156:159]
    v_mfma_f32_16x16x32_bf16 v[156:159], v[68:71], v[56:59], v[156:159]
    v_mfma_f32_16x16x32_bf16 v[156:159], v[64:67], v[52:55], v[156:159]
    s_waitcnt vmcnt(10)
    v_mfma_f32_16x16x32_bf16 v[160:163], v[76:79], v[16:19], v[160:163]
    v_mfma_f32_16x16x32_bf16 v[160:163], v[80:83], v[20:23], v[160:163]
    v_mfma_f32_16x16x32_bf16 v[160:163], v[84:87], v[24:27], v[160:163]
    v_mfma_f32_16x16x32_bf16 v[164:167], v[84:87], v[28:31], v[164:167]
    v_mfma_f32_16x16x32_bf16 v[164:167], v[80:83], v[24:27], v[164:167]
    buffer_load_dwordx4 v[64:67], v6, s[16:19], s52 offen offset:0 sc0 sc1
    v_mfma_f32_16x16x32_bf16 v[164:167], v[76:79], v[20:23], v[164:167]
    v_mfma_f32_16x16x32_bf16 v[168:171], v[76:79], v[24:27], v[168:171]
    v_mfma_f32_16x16x32_bf16 v[168:171], v[80:83], v[28:31], v[168:171]
    v_mfma_f32_16x16x32_bf16 v[168:171], v[84:87], v[32:35], v[168:171]
    v_mfma_f32_16x16x32_bf16 v[172:175], v[84:87], v[36:39], v[172:175]
    v_mfma_f32_16x16x32_bf16 v[172:175], v[80:83], v[32:35], v[172:175]
    buffer_load_dwordx4 v[68:71], v6, s[16:19], s52 offen offset:1024 sc0 sc1
    v_mfma_f32_16x16x32_bf16 v[172:175], v[76:79], v[28:31], v[172:175]
    v_mfma_f32_16x16x32_bf16 v[176:179], v[76:79], v[40:43], v[176:179]
    v_mfma_f32_16x16x32_bf16 v[176:179], v[80:83], v[44:47], v[176:179]
    v_mfma_f32_16x16x32_bf16 v[176:179], v[84:87], v[48:51], v[176:179]
    v_mfma_f32_16x16x32_bf16 v[180:183], v[84:87], v[52:55], v[180:183]
    v_mfma_f32_16x16x32_bf16 v[180:183], v[80:83], v[48:51], v[180:183]
    buffer_load_dwordx4 v[72:75], v6, s[16:19], s52 offen offset:2048 sc0 sc1
    v_mfma_f32_16x16x32_bf16 v[180:183], v[76:79], v[44:47], v[180:183]
    v_mfma_f32_16x16x32_bf16 v[184:187], v[76:79], v[48:51], v[184:187]
    v_mfma_f32_16x16x32_bf16 v[184:187], v[80:83], v[52:55], v[184:187]
    v_mfma_f32_16x16x32_bf16 v[184:187], v[84:87], v[56:59], v[184:187]
    s_add_u32 s52, s52, 3072
    v_mfma_f32_16x16x32_bf16 v[188:191], v[84:87], v[60:63], v[188:191]
    v_mfma_f32_16x16x32_bf16 v[188:191], v[80:83], v[56:59], v[188:191]
    v_mfma_f32_16x16x32_bf16 v[188:191], v[76:79], v[52:55], v[188:191]
    s_waitcnt vmcnt(10)
    v_mfma_f32_16x16x32_bf16 v[192:195], v[88:91], v[16:19], v[192:195]
    v_mfma_f32_16x16x32_bf16 v[192:195], v[92:95], v[20:23], v[192:195]
    v_mfma_f32_16x16x32_bf16 v[192:195], v[96:99], v[24:27], v[192:195]
    v_mfma_f32_16x16x32_bf16 v[196:199], v[96:99], v[28:31], v[196:199]
    v_mfma_f32_16x16x32_bf16 v[196:199], v[92:95], v[24:27], v[196:199]
    buffer_load_dwordx4 v[76:79], v6, s[16:19], s52 offen offset:0 sc0 sc1
    v_mfma_f32_16x16x32_bf16 v[196:199], v[88:91], v[20:23], v[196:199]
    v_mfma_f32_16x16x32_bf16 v[200:203], v[88:91], v[24:27], v[200:203]
    v_mfma_f32_16x16x32_bf16 v[200:203], v[92:95], v[28:31], v[200:203]
    v_mfma_f32_16x16x32_bf16 v[200:203], v[96:99], v[32:35], v[200:203]
    v_mfma_f32_16x16x32_bf16 v[204:207], v[96:99], v[36:39], v[204:207]
    v_mfma_f32_16x16x32_bf16 v[204:207], v[92:95], v[32:35], v[204:207]
    buffer_load_dwordx4 v[80:83], v6, s[16:19], s52 offen offset:1024 sc0 sc1
    v_mfma_f32_16x16x32_bf16 v[204:207], v[88:91], v[28:31], v[204:207]
    v_mfma_f32_16x16x32_bf16 v[208:211], v[88:91], v[40:43], v[208:211]
    v_mfma_f32_16x16x32_bf16 v[208:211], v[92:95], v[44:47], v[208:211]
    v_mfma_f32_16x16x32_bf16 v[208:211], v[96:99], v[48:51], v[208:211]
    v_mfma_f32_16x16x32_bf16 v[212:215], v[96:99], v[52:55], v[212:215]
    v_mfma_f32_16x16x32_bf16 v[212:215], v[92:95], v[48:51], v[212:215]
    buffer_load_dwordx4 v[84:87], v6, s[16:19], s52 offen offset:2048 sc0 sc1
    v_mfma_f32_16x16x32_bf16 v[212:215], v[88:91], v[44:47], v[212:215]
    v_mfma_f32_16x16x32_bf16 v[216:219], v[88:91], v[48:51], v[216:219]
    v_mfma_f32_16x16x32_bf16 v[216:219], v[92:95], v[52:55], v[216:219]
    v_mfma_f32_16x16x32_bf16 v[216:219], v[96:99], v[56:59], v[216:219]
    s_add_u32 s52, s52, 3072
    v_mfma_f32_16x16x32_bf16 v[220:223], v[96:99], v[60:63], v[220:223]
    v_mfma_f32_16x16x32_bf16 v[220:223], v[92:95], v[56:59], v[220:223]
    v_mfma_f32_16x16x32_bf16 v[220:223], v[88:91], v[52:55], v[220:223]
    s_waitcnt vmcnt(10)
    v_mfma_f32_16x16x32_bf16 v[224:227], v[100:103], v[16:19], v[224:227]
    v_mfma_f32_16x16x32_bf16 v[224:227], v[104:107], v[20:23], v[224:227]
    s_barrier
    v_mfma_f32_16x16x32_bf16 v[224:227], v[108:111], v[24:27], v[224:227]
    v_mfma_f32_16x16x32_bf16 v[228:231], v[108:111], v[28:31], v[228:231]
    ds_read_b128 v[16:19], v3 offset:9344
    v_mfma_f32_16x16x32_bf16 v[228:231], v[104:107], v[24:27], v[228:231]
    buffer_load_dwordx4 v[88:91], v6, s[16:19], s52 offen offset:0 sc0 sc1
    v_mfma_f32_16x16x32_bf16 v[228:231], v[100:103], v[20:23], v[228:231]
    v_mfma_f32_16x16x32_bf16 v[232:235], v[100:103], v[24:27], v[232:235]
    ds_read_b128 v[20:23], v4 offset:8320
    v_mfma_f32_16x16x32_bf16 v[232:235], v[104:107], v[28:31], v[232:235]
    v_mfma_f32_16x16x32_bf16 v[232:235], v[108:111], v[32:35], v[232:235]
    v_mfma_f32_16x16x32_bf16 v[236:239], v[108:111], v[36:39], v[236:239]
    ds_read_b128 v[24:27], v4 offset:10432
    v_mfma_f32_16x16x32_bf16 v[236:239], v[104:107], v[32:35], v[236:239]
    buffer_load_dwordx4 v[92:95], v6, s[16:19], s52 offen offset:1024 sc0 sc1
    v_mfma_f32_16x16x32_bf16 v[236:239], v[100:103], v[28:31], v[236:239]
    v_mfma_f32_16x16x32_bf16 v[240:243], v[100:103], v[40:43], v[240:243]
    ds_read_b128 v[28:31], v4 offset:11456
    v_mfma_f32_16x16x32_bf16 v[240:243], v[104:107], v[44:47], v[240:243]
    ds_read_b128 v[32:35], v4 offset:9408
    v_mfma_f32_16x16x32_bf16 v[240:243], v[108:111], v[48:51], v[240:243]
    ds_read_b128 v[36:39], v5 offset:8384
    v_mfma_f32_16x16x32_bf16 v[244:247], v[108:111], v[52:55], v[244:247]
    ds_read_b128 v[40:43], v3 offset:13504
    v_mfma_f32_16x16x32_bf16 v[244:247], v[104:107], v[48:51], v[244:247]
    buffer_load_dwordx4 v[96:99], v6, s[16:19], s52 offen offset:2048 sc0 sc1
    v_mfma_f32_16x16x32_bf16 v[244:247], v[100:103], v[44:47], v[244:247]
    v_mfma_f32_16x16x32_bf16 v[248:251], v[100:103], v[48:51], v[248:251]
    ds_read_b128 v[44:47], v4 offset:12480
    v_mfma_f32_16x16x32_bf16 v[248:251], v[104:107], v[52:55], v[248:251]
    v_mfma_f32_16x16x32_bf16 v[248:251], v[108:111], v[56:59], v[248:251]
    s_add_u32 s52, s52, 3072
    v_mfma_f32_16x16x32_bf16 v[252:255], v[108:111], v[60:63], v[252:255]
    ds_read_b128 v[48:51], v4 offset:14592
    v_mfma_f32_16x16x32_bf16 v[252:255], v[104:107], v[56:59], v[252:255]
    v_mfma_f32_16x16x32_bf16 v[252:255], v[100:103], v[52:55], v[252:255]
    s_waitcnt vmcnt(10) lgkmcnt(6)
    v_mfma_f32_16x16x32_bf16 v[128:131], v[112:115], v[16:19], v[128:131]
    ds_read_b128 v[52:55], v4 offset:15616
    v_mfma_f32_16x16x32_bf16 v[128:131], v[116:119], v[20:23], v[128:131]
    ds_read_b128 v[56:59], v4 offset:13568
    v_mfma_f32_16x16x32_bf16 v[128:131], v[120:123], v[24:27], v[128:131]
    ds_read_b128 v[60:63], v5 offset:12544
    s_waitcnt lgkmcnt(6)
    v_mfma_f32_16x16x32_bf16 v[132:135], v[120:123], v[28:31], v[132:135]
    v_mfma_f32_16x16x32_bf16 v[132:135], v[116:119], v[24:27], v[132:135]
    buffer_load_dwordx4 v[100:103], v6, s[16:19], s52 offen offset:0 sc0 sc1
    v_mfma_f32_16x16x32_bf16 v[132:135], v[112:115], v[20:23], v[132:135]
    v_mfma_f32_16x16x32_bf16 v[136:139], v[112:115], v[24:27], v[136:139]
    v_mfma_f32_16x16x32_bf16 v[136:139], v[116:119], v[28:31], v[136:139]
    v_mfma_f32_16x16x32_bf16 v[136:139], v[120:123], v[32:35], v[136:139]
    v_mfma_f32_16x16x32_bf16 v[140:143], v[120:123], v[36:39], v[140:143]
    v_mfma_f32_16x16x32_bf16 v[140:143], v[116:119], v[32:35], v[140:143]
    buffer_load_dwordx4 v[104:107], v6, s[16:19], s52 offen offset:1024 sc0 sc1
    v_mfma_f32_16x16x32_bf16 v[140:143], v[112:115], v[28:31], v[140:143]
    s_waitcnt lgkmcnt(3)
    v_mfma_f32_16x16x32_bf16 v[144:147], v[112:115], v[40:43], v[144:147]
    v_mfma_f32_16x16x32_bf16 v[144:147], v[116:119], v[44:47], v[144:147]
    v_mfma_f32_16x16x32_bf16 v[144:147], v[120:123], v[48:51], v[144:147]
    s_waitcnt lgkmcnt(0)
    v_mfma_f32_16x16x32_bf16 v[148:151], v[120:123], v[52:55], v[148:151]
    v_mfma_f32_16x16x32_bf16 v[148:151], v[116:119], v[48:51], v[148:151]
    buffer_load_dwordx4 v[108:111], v6, s[16:19], s52 offen offset:2048 sc0 sc1
    v_mfma_f32_16x16x32_bf16 v[148:151], v[112:115], v[44:47], v[148:151]
    v_mfma_f32_16x16x32_bf16 v[152:155], v[112:115], v[48:51], v[152:155]
    v_mfma_f32_16x16x32_bf16 v[152:155], v[116:119], v[52:55], v[152:155]
    v_mfma_f32_16x16x32_bf16 v[152:155], v[120:123], v[56:59], v[152:155]
    s_add_u32 s52, s52, 3072
    v_mfma_f32_16x16x32_bf16 v[156:159], v[120:123], v[60:63], v[156:159]
    v_mfma_f32_16x16x32_bf16 v[156:159], v[116:119], v[56:59], v[156:159]
    v_mfma_f32_16x16x32_bf16 v[156:159], v[112:115], v[52:55], v[156:159]
    s_waitcnt vmcnt(10)
    v_mfma_f32_16x16x32_bf16 v[160:163], v[124:127], v[16:19], v[160:163]
    v_mfma_f32_16x16x32_bf16 v[160:163], v[64:67], v[20:23], v[160:163]
    v_mfma_f32_16x16x32_bf16 v[160:163], v[68:71], v[24:27], v[160:163]
    v_mfma_f32_16x16x32_bf16 v[164:167], v[68:71], v[28:31], v[164:167]
    v_mfma_f32_16x16x32_bf16 v[164:167], v[64:67], v[24:27], v[164:167]
    buffer_load_dwordx4 v[112:115], v6, s[16:19], s52 offen offset:0 sc0 sc1
    v_mfma_f32_16x16x32_bf16 v[164:167], v[124:127], v[20:23], v[164:167]
    v_mfma_f32_16x16x32_bf16 v[168:171], v[124:127], v[24:27], v[168:171]
    v_mfma_f32_16x16x32_bf16 v[168:171], v[64:67], v[28:31], v[168:171]
    v_mfma_f32_16x16x32_bf16 v[168:171], v[68:71], v[32:35], v[168:171]
    v_mfma_f32_16x16x32_bf16 v[172:175], v[68:71], v[36:39], v[172:175]
    v_mfma_f32_16x16x32_bf16 v[172:175], v[64:67], v[32:35], v[172:175]
    buffer_load_dwordx4 v[116:119], v6, s[16:19], s52 offen offset:1024 sc0 sc1
    v_mfma_f32_16x16x32_bf16 v[172:175], v[124:127], v[28:31], v[172:175]
    v_mfma_f32_16x16x32_bf16 v[176:179], v[124:127], v[40:43], v[176:179]
    v_mfma_f32_16x16x32_bf16 v[176:179], v[64:67], v[44:47], v[176:179]
    v_mfma_f32_16x16x32_bf16 v[176:179], v[68:71], v[48:51], v[176:179]
    v_mfma_f32_16x16x32_bf16 v[180:183], v[68:71], v[52:55], v[180:183]
    v_mfma_f32_16x16x32_bf16 v[180:183], v[64:67], v[48:51], v[180:183]
    buffer_load_dwordx4 v[120:123], v6, s[16:19], s52 offen offset:2048 sc0 sc1
    v_mfma_f32_16x16x32_bf16 v[180:183], v[124:127], v[44:47], v[180:183]
    v_mfma_f32_16x16x32_bf16 v[184:187], v[124:127], v[48:51], v[184:187]
    v_mfma_f32_16x16x32_bf16 v[184:187], v[64:67], v[52:55], v[184:187]
    v_mfma_f32_16x16x32_bf16 v[184:187], v[68:71], v[56:59], v[184:187]
    s_add_u32 s52, s52, 3072
    v_mfma_f32_16x16x32_bf16 v[188:191], v[68:71], v[60:63], v[188:191]
    v_mfma_f32_16x16x32_bf16 v[188:191], v[64:67], v[56:59], v[188:191]
    v_mfma_f32_16x16x32_bf16 v[188:191], v[124:127], v[52:55], v[188:191]
    s_waitcnt vmcnt(10)
    v_mfma_f32_16x16x32_bf16 v[192:195], v[72:75], v[16:19], v[192:195]
    v_mfma_f32_16x16x32_bf16 v[192:195], v[76:79], v[20:23], v[192:195]
    v_mfma_f32_16x16x32_bf16 v[192:195], v[80:83], v[24:27], v[192:195]
    v_mfma_f32_16x16x32_bf16 v[196:199], v[80:83], v[28:31], v[196:199]
    v_mfma_f32_16x16x32_bf16 v[196:199], v[76:79], v[24:27], v[196:199]
    buffer_load_dwordx4 v[124:127], v6, s[16:19], s52 offen offset:0 sc0 sc1
    v_mfma_f32_16x16x32_bf16 v[196:199], v[72:75], v[20:23], v[196:199]
    v_mfma_f32_16x16x32_bf16 v[200:203], v[72:75], v[24:27], v[200:203]
    v_mfma_f32_16x16x32_bf16 v[200:203], v[76:79], v[28:31], v[200:203]
    v_mfma_f32_16x16x32_bf16 v[200:203], v[80:83], v[32:35], v[200:203]
    v_mfma_f32_16x16x32_bf16 v[204:207], v[80:83], v[36:39], v[204:207]
    v_mfma_f32_16x16x32_bf16 v[204:207], v[76:79], v[32:35], v[204:207]
    buffer_load_dwordx4 v[64:67], v6, s[16:19], s52 offen offset:1024 sc0 sc1
    v_mfma_f32_16x16x32_bf16 v[204:207], v[72:75], v[28:31], v[204:207]
    v_mfma_f32_16x16x32_bf16 v[208:211], v[72:75], v[40:43], v[208:211]
    v_mfma_f32_16x16x32_bf16 v[208:211], v[76:79], v[44:47], v[208:211]
    v_mfma_f32_16x16x32_bf16 v[208:211], v[80:83], v[48:51], v[208:211]
    v_mfma_f32_16x16x32_bf16 v[212:215], v[80:83], v[52:55], v[212:215]
    v_mfma_f32_16x16x32_bf16 v[212:215], v[76:79], v[48:51], v[212:215]
    buffer_load_dwordx4 v[68:71], v6, s[16:19], s52 offen offset:2048 sc0 sc1
    v_mfma_f32_16x16x32_bf16 v[212:215], v[72:75], v[44:47], v[212:215]
    v_mfma_f32_16x16x32_bf16 v[216:219], v[72:75], v[48:51], v[216:219]
    v_mfma_f32_16x16x32_bf16 v[216:219], v[76:79], v[52:55], v[216:219]
    v_mfma_f32_16x16x32_bf16 v[216:219], v[80:83], v[56:59], v[216:219]
    s_add_u32 s52, s52, 3072
    v_mfma_f32_16x16x32_bf16 v[220:223], v[80:83], v[60:63], v[220:223]
    v_mfma_f32_16x16x32_bf16 v[220:223], v[76:79], v[56:59], v[220:223]
    v_mfma_f32_16x16x32_bf16 v[220:223], v[72:75], v[52:55], v[220:223]
    s_waitcnt vmcnt(10)
    v_mfma_f32_16x16x32_bf16 v[224:227], v[84:87], v[16:19], v[224:227]
    v_mfma_f32_16x16x32_bf16 v[224:227], v[88:91], v[20:23], v[224:227]
    s_barrier
    v_mfma_f32_16x16x32_bf16 v[224:227], v[92:95], v[24:27], v[224:227]
    v_mfma_f32_16x16x32_bf16 v[228:231], v[92:95], v[28:31], v[228:231]
    ds_read_b128 v[16:19], v3 offset:17664
    v_mfma_f32_16x16x32_bf16 v[228:231], v[88:91], v[24:27], v[228:231]
    buffer_load_dwordx4 v[72:75], v6, s[16:19], s52 offen offset:0 sc0 sc1
    v_mfma_f32_16x16x32_bf16 v[228:231], v[84:87], v[20:23], v[228:231]
    v_mfma_f32_16x16x32_bf16 v[232:235], v[84:87], v[24:27], v[232:235]
    ds_read_b128 v[20:23], v4 offset:16640
    v_mfma_f32_16x16x32_bf16 v[232:235], v[88:91], v[28:31], v[232:235]
    v_mfma_f32_16x16x32_bf16 v[232:235], v[92:95], v[32:35], v[232:235]
    v_mfma_f32_16x16x32_bf16 v[236:239], v[92:95], v[36:39], v[236:239]
    ds_read_b128 v[24:27], v4 offset:18752
    v_mfma_f32_16x16x32_bf16 v[236:239], v[88:91], v[32:35], v[236:239]
    buffer_load_dwordx4 v[76:79], v6, s[16:19], s52 offen offset:1024 sc0 sc1
    v_mfma_f32_16x16x32_bf16 v[236:239], v[84:87], v[28:31], v[236:239]
    v_mfma_f32_16x16x32_bf16 v[240:243], v[84:87], v[40:43], v[240:243]
    ds_read_b128 v[28:31], v4 offset:19776
    v_mfma_f32_16x16x32_bf16 v[240:243], v[88:91], v[44:47], v[240:243]
    ds_read_b128 v[32:35], v4 offset:17728
    v_mfma_f32_16x16x32_bf16 v[240:243], v[92:95], v[48:51], v[240:243]
    ds_read_b128 v[36:39], v5 offset:16704
    v_mfma_f32_16x16x32_bf16 v[244:247], v[92:95], v[52:55], v[244:247]
    ds_read_b128 v[40:43], v3 offset:21824
    v_mfma_f32_16x16x32_bf16 v[244:247], v[88:91], v[48:51], v[244:247]
    buffer_load_dwordx4 v[80:83], v6, s[16:19], s52 offen offset:2048 sc0 sc1
    v_mfma_f32_16x16x32_bf16 v[244:247], v[84:87], v[44:47], v[244:247]
    v_mfma_f32_16x16x32_bf16 v[248:251], v[84:87], v[48:51], v[248:251]
    ds_read_b128 v[44:47], v4 offset:20800
    v_mfma_f32_16x16x32_bf16 v[248:251], v[88:91], v[52:55], v[248:251]
    v_mfma_f32_16x16x32_bf16 v[248:251], v[92:95], v[56:59], v[248:251]
    s_add_u32 s52, s52, 3072
    v_mfma_f32_16x16x32_bf16 v[252:255], v[92:95], v[60:63], v[252:255]
    ds_read_b128 v[48:51], v4 offset:22912
    v_mfma_f32_16x16x32_bf16 v[252:255], v[88:91], v[56:59], v[252:255]
    v_mfma_f32_16x16x32_bf16 v[252:255], v[84:87], v[52:55], v[252:255]
    s_waitcnt vmcnt(10) lgkmcnt(6)
    v_mfma_f32_16x16x32_bf16 v[128:131], v[96:99], v[16:19], v[128:131]
    ds_read_b128 v[52:55], v4 offset:23936
    v_mfma_f32_16x16x32_bf16 v[128:131], v[100:103], v[20:23], v[128:131]
    ds_read_b128 v[56:59], v4 offset:21888
    v_mfma_f32_16x16x32_bf16 v[128:131], v[104:107], v[24:27], v[128:131]
    ds_read_b128 v[60:63], v5 offset:20864
    s_waitcnt lgkmcnt(6)
    v_mfma_f32_16x16x32_bf16 v[132:135], v[104:107], v[28:31], v[132:135]
    v_mfma_f32_16x16x32_bf16 v[132:135], v[100:103], v[24:27], v[132:135]
    buffer_load_dwordx4 v[84:87], v6, s[16:19], s52 offen offset:0 sc0 sc1
    v_mfma_f32_16x16x32_bf16 v[132:135], v[96:99], v[20:23], v[132:135]
    v_mfma_f32_16x16x32_bf16 v[136:139], v[96:99], v[24:27], v[136:139]
    v_mfma_f32_16x16x32_bf16 v[136:139], v[100:103], v[28:31], v[136:139]
    v_mfma_f32_16x16x32_bf16 v[136:139], v[104:107], v[32:35], v[136:139]
    v_mfma_f32_16x16x32_bf16 v[140:143], v[104:107], v[36:39], v[140:143]
    v_mfma_f32_16x16x32_bf16 v[140:143], v[100:103], v[32:35], v[140:143]
    buffer_load_dwordx4 v[88:91], v6, s[16:19], s52 offen offset:1024 sc0 sc1
    v_mfma_f32_16x16x32_bf16 v[140:143], v[96:99], v[28:31], v[140:143]
    s_waitcnt lgkmcnt(3)
    v_mfma_f32_16x16x32_bf16 v[144:147], v[96:99], v[40:43], v[144:147]
    v_mfma_f32_16x16x32_bf16 v[144:147], v[100:103], v[44:47], v[144:147]
    v_mfma_f32_16x16x32_bf16 v[144:147], v[104:107], v[48:51], v[144:147]
    s_waitcnt lgkmcnt(0)
    v_mfma_f32_16x16x32_bf16 v[148:151], v[104:107], v[52:55], v[148:151]
    v_mfma_f32_16x16x32_bf16 v[148:151], v[100:103], v[48:51], v[148:151]
    buffer_load_dwordx4 v[92:95], v6, s[16:19], s52 offen offset:2048 sc0 sc1
    v_mfma_f32_16x16x32_bf16 v[148:151], v[96:99], v[44:47], v[148:151]
    v_mfma_f32_16x16x32_bf16 v[152:155], v[96:99], v[48:51], v[152:155]
    v_mfma_f32_16x16x32_bf16 v[152:155], v[100:103], v[52:55], v[152:155]
    v_mfma_f32_16x16x32_bf16 v[152:155], v[104:107], v[56:59], v[152:155]
    s_add_u32 s52, s52, 3072
    v_mfma_f32_16x16x32_bf16 v[156:159], v[104:107], v[60:63], v[156:159]
    v_mfma_f32_16x16x32_bf16 v[156:159], v[100:103], v[56:59], v[156:159]
    v_mfma_f32_16x16x32_bf16 v[156:159], v[96:99], v[52:55], v[156:159]
    s_waitcnt vmcnt(10)
    v_mfma_f32_16x16x32_bf16 v[160:163], v[108:111], v[16:19], v[160:163]
    v_mfma_f32_16x16x32_bf16 v[160:163], v[112:115], v[20:23], v[160:163]
    v_mfma_f32_16x16x32_bf16 v[160:163], v[116:119], v[24:27], v[160:163]
    v_mfma_f32_16x16x32_bf16 v[164:167], v[116:119], v[28:31], v[164:167]
    v_mfma_f32_16x16x32_bf16 v[164:167], v[112:115], v[24:27], v[164:167]
    buffer_load_dwordx4 v[96:99], v6, s[16:19], s52 offen offset:0 sc0 sc1
    v_mfma_f32_16x16x32_bf16 v[164:167], v[108:111], v[20:23], v[164:167]
    v_mfma_f32_16x16x32_bf16 v[168:171], v[108:111], v[24:27], v[168:171]
    v_mfma_f32_16x16x32_bf16 v[168:171], v[112:115], v[28:31], v[168:171]
    v_mfma_f32_16x16x32_bf16 v[168:171], v[116:119], v[32:35], v[168:171]
    v_mfma_f32_16x16x32_bf16 v[172:175], v[116:119], v[36:39], v[172:175]
    v_mfma_f32_16x16x32_bf16 v[172:175], v[112:115], v[32:35], v[172:175]
    buffer_load_dwordx4 v[100:103], v6, s[16:19], s52 offen offset:1024 sc0 sc1
    v_mfma_f32_16x16x32_bf16 v[172:175], v[108:111], v[28:31], v[172:175]
    v_mfma_f32_16x16x32_bf16 v[176:179], v[108:111], v[40:43], v[176:179]
    v_mfma_f32_16x16x32_bf16 v[176:179], v[112:115], v[44:47], v[176:179]
    v_mfma_f32_16x16x32_bf16 v[176:179], v[116:119], v[48:51], v[176:179]
    v_mfma_f32_16x16x32_bf16 v[180:183], v[116:119], v[52:55], v[180:183]
    v_mfma_f32_16x16x32_bf16 v[180:183], v[112:115], v[48:51], v[180:183]
    buffer_load_dwordx4 v[104:107], v6, s[16:19], s52 offen offset:2048 sc0 sc1
    v_mfma_f32_16x16x32_bf16 v[180:183], v[108:111], v[44:47], v[180:183]
    v_mfma_f32_16x16x32_bf16 v[184:187], v[108:111], v[48:51], v[184:187]
    v_mfma_f32_16x16x32_bf16 v[184:187], v[112:115], v[52:55], v[184:187]
    v_mfma_f32_16x16x32_bf16 v[184:187], v[116:119], v[56:59], v[184:187]
    s_add_u32 s52, s52, 3072
    v_mfma_f32_16x16x32_bf16 v[188:191], v[116:119], v[60:63], v[188:191]
    v_mfma_f32_16x16x32_bf16 v[188:191], v[112:115], v[56:59], v[188:191]
    v_mfma_f32_16x16x32_bf16 v[188:191], v[108:111], v[52:55], v[188:191]
    s_waitcnt vmcnt(10)
    v_mfma_f32_16x16x32_bf16 v[192:195], v[120:123], v[16:19], v[192:195]
    v_mfma_f32_16x16x32_bf16 v[192:195], v[124:127], v[20:23], v[192:195]
    v_mfma_f32_16x16x32_bf16 v[192:195], v[64:67], v[24:27], v[192:195]
    v_mfma_f32_16x16x32_bf16 v[196:199], v[64:67], v[28:31], v[196:199]
    v_mfma_f32_16x16x32_bf16 v[196:199], v[124:127], v[24:27], v[196:199]
    buffer_load_dwordx4 v[108:111], v6, s[16:19], s52 offen offset:0 sc0 sc1
    v_mfma_f32_16x16x32_bf16 v[196:199], v[120:123], v[20:23], v[196:199]
    v_mfma_f32_16x16x32_bf16 v[200:203], v[120:123], v[24:27], v[200:203]
    v_mfma_f32_16x16x32_bf16 v[200:203], v[124:127], v[28:31], v[200:203]
    v_mfma_f32_16x16x32_bf16 v[200:203], v[64:67], v[32:35], v[200:203]
    v_mfma_f32_16x16x32_bf16 v[204:207], v[64:67], v[36:39], v[204:207]
    v_mfma_f32_16x16x32_bf16 v[204:207], v[124:127], v[32:35], v[204:207]
    buffer_load_dwordx4 v[112:115], v6, s[16:19], s52 offen offset:1024 sc0 sc1
    v_mfma_f32_16x16x32_bf16 v[204:207], v[120:123], v[28:31], v[204:207]
    v_mfma_f32_16x16x32_bf16 v[208:211], v[120:123], v[40:43], v[208:211]
    v_mfma_f32_16x16x32_bf16 v[208:211], v[124:127], v[44:47], v[208:211]
    v_mfma_f32_16x16x32_bf16 v[208:211], v[64:67], v[48:51], v[208:211]
    v_mfma_f32_16x16x32_bf16 v[212:215], v[64:67], v[52:55], v[212:215]
    v_mfma_f32_16x16x32_bf16 v[212:215], v[124:127], v[48:51], v[212:215]
    buffer_load_dwordx4 v[116:119], v6, s[16:19], s52 offen offset:2048 sc0 sc1
    v_mfma_f32_16x16x32_bf16 v[212:215], v[120:123], v[44:47], v[212:215]
    v_mfma_f32_16x16x32_bf16 v[216:219], v[120:123], v[48:51], v[216:219]
    v_mfma_f32_16x16x32_bf16 v[216:219], v[124:127], v[52:55], v[216:219]
    v_mfma_f32_16x16x32_bf16 v[216:219], v[64:67], v[56:59], v[216:219]
    s_add_u32 s52, s52, 3072
    v_mfma_f32_16x16x32_bf16 v[220:223], v[64:67], v[60:63], v[220:223]
    v_mfma_f32_16x16x32_bf16 v[220:223], v[124:127], v[56:59], v[220:223]
    v_mfma_f32_16x16x32_bf16 v[220:223], v[120:123], v[52:55], v[220:223]
    s_waitcnt vmcnt(10)
    v_mfma_f32_16x16x32_bf16 v[224:227], v[68:71], v[16:19], v[224:227]
    v_mfma_f32_16x16x32_bf16 v[224:227], v[72:75], v[20:23], v[224:227]
    s_barrier
    v_mfma_f32_16x16x32_bf16 v[224:227], v[76:79], v[24:27], v[224:227]
    v_mfma_f32_16x16x32_bf16 v[228:231], v[76:79], v[28:31], v[228:231]
    ds_read_b128 v[16:19], v3 offset:25984
    v_mfma_f32_16x16x32_bf16 v[228:231], v[72:75], v[24:27], v[228:231]
    buffer_load_dwordx4 v[120:123], v6, s[16:19], s52 offen offset:0 sc0 sc1
    v_mfma_f32_16x16x32_bf16 v[228:231], v[68:71], v[20:23], v[228:231]
    v_mfma_f32_16x16x32_bf16 v[232:235], v[68:71], v[24:27], v[232:235]
    ds_read_b128 v[20:23], v4 offset:24960
    v_mfma_f32_16x16x32_bf16 v[232:235], v[72:75], v[28:31], v[232:235]
    v_mfma_f32_16x16x32_bf16 v[232:235], v[76:79], v[32:35], v[232:235]
    v_mfma_f32_16x16x32_bf16 v[236:239], v[76:79], v[36:39], v[236:239]
    ds_read_b128 v[24:27], v4 offset:27072
    v_mfma_f32_16x16x32_bf16 v[236:239], v[72:75], v[32:35], v[236:239]
    buffer_load_dwordx4 v[124:127], v6, s[16:19], s52 offen offset:1024 sc0 sc1
    v_mfma_f32_16x16x32_bf16 v[236:239], v[68:71], v[28:31], v[236:239]
    v_mfma_f32_16x16x32_bf16 v[240:243], v[68:71], v[40:43], v[240:243]
    ds_read_b128 v[28:31], v4 offset:28096
    v_mfma_f32_16x16x32_bf16 v[240:243], v[72:75], v[44:47], v[240:243]
    ds_read_b128 v[32:35], v4 offset:26048
    v_mfma_f32_16x16x32_bf16 v[240:243], v[76:79], v[48:51], v[240:243]
    ds_read_b128 v[36:39], v5 offset:25024
    v_mfma_f32_16x16x32_bf16 v[244:247], v[76:79], v[52:55], v[244:247]
    ds_read_b128 v[40:43], v3 offset:30144
    v_mfma_f32_16x16x32_bf16 v[244:247], v[72:75], v[48:51], v[244:247]
    buffer_load_dwordx4 v[64:67], v6, s[16:19], s52 offen offset:2048 sc0 sc1
    v_mfma_f32_16x16x32_bf16 v[244:247], v[68:71], v[44:47], v[244:247]
    v_mfma_f32_16x16x32_bf16 v[248:251], v[68:71], v[48:51], v[248:251]
    ds_read_b128 v[44:47], v4 offset:29120
    v_mfma_f32_16x16x32_bf16 v[248:251], v[72:75], v[52:55], v[248:251]
    v_mfma_f32_16x16x32_bf16 v[248:251], v[76:79], v[56:59], v[248:251]
    s_add_u32 s52, s52, 3072
    v_mfma_f32_16x16x32_bf16 v[252:255], v[76:79], v[60:63], v[252:255]
    ds_read_b128 v[48:51], v4 offset:31232
    v_mfma_f32_16x16x32_bf16 v[252:255], v[72:75], v[56:59], v[252:255]
    v_mfma_f32_16x16x32_bf16 v[252:255], v[68:71], v[52:55], v[252:255]
    s_waitcnt vmcnt(10) lgkmcnt(6)
    v_mfma_f32_16x16x32_bf16 v[128:131], v[80:83], v[16:19], v[128:131]
    ds_read_b128 v[52:55], v4 offset:32256
    v_mfma_f32_16x16x32_bf16 v[128:131], v[84:87], v[20:23], v[128:131]
    ds_read_b128 v[56:59], v4 offset:30208
    v_mfma_f32_16x16x32_bf16 v[128:131], v[88:91], v[24:27], v[128:131]
    ds_read_b128 v[60:63], v5 offset:29184
    s_waitcnt lgkmcnt(6)
    v_mfma_f32_16x16x32_bf16 v[132:135], v[88:91], v[28:31], v[132:135]
    v_mfma_f32_16x16x32_bf16 v[132:135], v[84:87], v[24:27], v[132:135]
    buffer_load_dwordx4 v[68:71], v6, s[16:19], s52 offen offset:0 sc0 sc1
    v_mfma_f32_16x16x32_bf16 v[132:135], v[80:83], v[20:23], v[132:135]
    v_mfma_f32_16x16x32_bf16 v[136:139], v[80:83], v[24:27], v[136:139]
    v_mfma_f32_16x16x32_bf16 v[136:139], v[84:87], v[28:31], v[136:139]
    v_mfma_f32_16x16x32_bf16 v[136:139], v[88:91], v[32:35], v[136:139]
    v_mfma_f32_16x16x32_bf16 v[140:143], v[88:91], v[36:39], v[140:143]
    v_mfma_f32_16x16x32_bf16 v[140:143], v[84:87], v[32:35], v[140:143]
    buffer_load_dwordx4 v[72:75], v6, s[16:19], s52 offen offset:1024 sc0 sc1
    v_mfma_f32_16x16x32_bf16 v[140:143], v[80:83], v[28:31], v[140:143]
    s_waitcnt lgkmcnt(3)
    v_mfma_f32_16x16x32_bf16 v[144:147], v[80:83], v[40:43], v[144:147]
    v_mfma_f32_16x16x32_bf16 v[144:147], v[84:87], v[44:47], v[144:147]
    v_mfma_f32_16x16x32_bf16 v[144:147], v[88:91], v[48:51], v[144:147]
    s_waitcnt lgkmcnt(0)
    v_mfma_f32_16x16x32_bf16 v[148:151], v[88:91], v[52:55], v[148:151]
    v_mfma_f32_16x16x32_bf16 v[148:151], v[84:87], v[48:51], v[148:151]
    buffer_load_dwordx4 v[76:79], v6, s[16:19], s52 offen offset:2048 sc0 sc1
    v_mfma_f32_16x16x32_bf16 v[148:151], v[80:83], v[44:47], v[148:151]
    v_mfma_f32_16x16x32_bf16 v[152:155], v[80:83], v[48:51], v[152:155]
    v_mfma_f32_16x16x32_bf16 v[152:155], v[84:87], v[52:55], v[152:155]
    v_mfma_f32_16x16x32_bf16 v[152:155], v[88:91], v[56:59], v[152:155]
    s_add_u32 s52, s52, 3072
    v_mfma_f32_16x16x32_bf16 v[156:159], v[88:91], v[60:63], v[156:159]
    v_mfma_f32_16x16x32_bf16 v[156:159], v[84:87], v[56:59], v[156:159]
    s_cmp_eq_u32 s53, 3
    v_mfma_f32_16x16x32_bf16 v[156:159], v[80:83], v[52:55], v[156:159]
    s_cbranch_scc1 L_last
    s_waitcnt vmcnt(10)
    v_mfma_f32_16x16x32_bf16 v[160:163], v[92:95], v[16:19], v[160:163]
    v_mfma_f32_16x16x32_bf16 v[160:163], v[96:99], v[20:23], v[160:163]
    v_mfma_f32_16x16x32_bf16 v[160:163], v[100:103], v[24:27], v[160:163]
    v_mfma_f32_16x16x32_bf16 v[164:167], v[100:103], v[28:31], v[164:167]
    v_mfma_f32_16x16x32_bf16 v[164:167], v[96:99], v[24:27], v[164:167]
    buffer_load_dwordx4 v[80:83], v6, s[16:19], s52 offen offset:0 sc0 sc1
    v_mfma_f32_16x16x32_bf16 v[164:167], v[92:95], v[20:23], v[164:167]
    v_mfma_f32_16x16x32_bf16 v[168:171], v[92:95], v[24:27], v[168:171]
    v_mfma_f32_16x16x32_bf16 v[168:171], v[96:99], v[28:31], v[168:171]
    v_mfma_f32_16x16x32_bf16 v[168:171], v[100:103], v[32:35], v[168:171]
    v_mfma_f32_16x16x32_bf16 v[172:175], v[100:103], v[36:39], v[172:175]
    v_mfma_f32_16x16x32_bf16 v[172:175], v[96:99], v[32:35], v[172:175]
    buffer_load_dwordx4 v[84:87], v6, s[16:19], s52 offen offset:1024 sc0 sc1
    v_mfma_f32_16x16x32_bf16 v[172:175], v[92:95], v[28:31], v[172:175]
    v_mfma_f32_16x16x32_bf16 v[176:179], v[92:95], v[40:43], v[176:179]
    v_mfma_f32_16x16x32_bf16 v[176:179], v[96:99], v[44:47], v[176:179]
    v_mfma_f32_16x16x32_bf16 v[176:179], v[100:103], v[48:51], v[176:179]
    v_mfma_f32_16x16x32_bf16 v[180:183], v[100:103], v[52:55], v[180:183]
    v_mfma_f32_16x16x32_bf16 v[180:183], v[96:99], v[48:51], v[180:183]
    buffer_load_dwordx4 v[88:91], v6, s[16:19], s52 offen offset:2048 sc0 sc1
    v_mfma_f32_16x16x32_bf16 v[180:183], v[92:95], v[44:47], v[180:183]
    v_mfma_f32_16x16x32_bf16 v[184:187], v[92:95], v[48:51], v[184:187]
    v_mfma_f32_16x16x32_bf16 v[184:187], v[96:99], v[52:55], v[184:187]
    v_mfma_f32_16x16x32_bf16 v[184:187], v[100:103], v[56:59], v[184:187]
    s_add_u32 s52, s52, 3072
    v_mfma_f32_16x16x32_bf16 v[188:191], v[100:103], v[60:63], v[188:191]
    v_mfma_f32_16x16x32_bf16 v[188:191], v[96:99], v[56:59], v[188:191]
    v_mfma_f32_16x16x32_bf16 v[188:191], v[92:95], v[52:55], v[188:191]
    s_waitcnt vmcnt(10)
    v_mfma_f32_16x16x32_bf16 v[192:195], v[104:107], v[16:19], v[192:195]
    v_mfma_f32_16x16x32_bf16 v[192:195], v[108:111], v[20:23], v[192:195]
    v_mfma_f32_16x16x32_bf16 v[192:195], v[112:115], v[24:27], v[192:195]
    v_mfma_f32_16x16x32_bf16 v[196:199], v[112:115], v[28:31], v[196:199]
    v_mfma_f32_16x16x32_bf16 v[196:199], v[108:111], v[24:27], v[196:199]
    buffer_load_dwordx4 v[92:95], v6, s[16:19], s52 offen offset:0 sc0 sc1
    v_mfma_f32_16x16x32_bf16 v[196:199], v[104:107], v[20:23], v[196:199]
    v_mfma_f32_16x16x32_bf16 v[200:203], v[104:107], v[24:27], v[200:203]
    v_mfma_f32_16x16x32_bf16 v[200:203], v[108:111], v[28:31], v[200:203]
    v_mfma_f32_16x16x32_bf16 v[200:203], v[112:115], v[32:35], v[200:203]
    v_mfma_f32_16x16x32_bf16 v[204:207], v[112:115], v[36:39], v[204:207]
    v_mfma_f32_16x16x32_bf16 v[204:207], v[108:111], v[32:35], v[204:207]
    buffer_load_dwordx4 v[96:99], v6, s[16:19], s52 offen offset:1024 sc0 sc1
    v_mfma_f32_16x16x32_bf16 v[204:207], v[104:107], v[28:31], v[204:207]
    v_mfma_f32_16x16x32_bf16 v[208:211], v[104:107], v[40:43], v[208:211]
    v_mfma_f32_16x16x32_bf16 v[208:211], v[108:111], v[44:47], v[208:211]
    v_mfma_f32_16x16x32_bf16 v[208:211], v[112:115], v[48:51], v[208:211]
    v_mfma_f32_16x16x32_bf16 v[212:215], v[112:115], v[52:55], v[212:215]
    v_mfma_f32_16x16x32_bf16 v[212:215], v[108:111], v[48:51], v[212:215]
    buffer_load_dwordx4 v[100:103], v6, s[16:19], s52 offen offset:2048 sc0 sc1
    v_mfma_f32_16x16x32_bf16 v[212:215], v[104:107], v[44:47], v[212:215]
    v_mfma_f32_16x16x32_bf16 v[216:219], v[104:107], v[48:51], v[216:219]
    v_mfma_f32_16x16x32_bf16 v[216:219], v[108:111], v[52:55], v[216:219]
    v_mfma_f32_16x16x32_bf16 v[216:219], v[112:115], v[56:59], v[216:219]
    s_add_u32 s52, s52, 3072
    v_mfma_f32_16x16x32_bf16 v[220:223], v[112:115], v[60:63], v[220:223]
    v_mfma_f32_16x16x32_bf16 v[220:223], v[108:111], v[56:59], v[220:223]
    v_mfma_f32_16x16x32_bf16 v[220:223], v[104:107], v[52:55], v[220:223]
    s_waitcnt vmcnt(10)
    v_mfma_f32_16x16x32_bf16 v[224:227], v[116:119], v[16:19], v[224:227]
    v_mfma_f32_16x16x32_bf16 v[224:227], v[120:123], v[20:23], v[224:227]
    s_barrier
    v_mfma_f32_16x16x32_bf16 v[224:227], v[124:127], v[24:27], v[224:227]
    v_mfma_f32_16x16x32_bf16 v[228:231], v[124:127], v[28:31], v[228:231]
    ds_read_b128 v[16:19], v3 offset:1024
    v_mfma_f32_16x16x32_bf16 v[228:231], v[120:123], v[24:27], v[228:231]
    buffer_load_dwordx4 v[104:107], v6, s[16:19], s52 offen offset:0 sc0 sc1
    v_mfma_f32_16x16x32_bf16 v[228:231], v[116:119], v[20:23], v[228:231]
    v_mfma_f32_16x16x32_bf16 v[232:235], v[116:119], v[24:27], v[232:235]
    ds_read_b128 v[20:23], v4 offset:0
    v_mfma_f32_16x16x32_bf16 v[232:235], v[120:123], v[28:31], v[232:235]
    v_mfma_f32_16x16x32_bf16 v[232:235], v[124:127], v[32:35], v[232:235]
    v_mfma_f32_16x16x32_bf16 v[236:239], v[124:127], v[36:39], v[236:239]
    ds_read_b128 v[24:27], v4 offset:2112
    v_mfma_f32_16x16x32_bf16 v[236:239], v[120:123], v[32:35], v[236:239]
    buffer_load_dwordx4 v[108:111], v6, s[16:19], s52 offen offset:1024 sc0 sc1
    v_mfma_f32_16x16x32_bf16 v[236:239], v[116:119], v[28:31], v[236:239]
    v_mfma_f32_16x16x32_bf16 v[240:243], v[116:119], v[40:43], v[240:243]
    ds_read_b128 v[28:31], v4 offset:3136
    v_mfma_f32_16x16x32_bf16 v[240:243], v[120:123], v[44:47], v[240:243]
    ds_read_b128 v[32:35], v4 offset:1088
    v_mfma_f32_16x16x32_bf16 v[240:243], v[124:127], v[48:51], v[240:243]
    ds_read_b128 v[36:39], v5 offset:64
    v_mfma_f32_16x16x32_bf16 v[244:247], v[124:127], v[52:55], v[244:247]
    ds_read_b128 v[40:43], v3 offset:5184
    v_mfma_f32_16x16x32_bf16 v[244:247], v[120:123], v[48:51], v[244:247]
    buffer_load_dwordx4 v[112:115], v6, s[16:19], s52 offen offset:2048 sc0 sc1
    v_mfma_f32_16x16x32_bf16 v[244:247], v[116:119], v[44:47], v[244:247]
    v_mfma_f32_16x16x32_bf16 v[248:251], v[116:119], v[48:51], v[248:251]
    ds_read_b128 v[44:47], v4 offset:4160
    v_mfma_f32_16x16x32_bf16 v[248:251], v[120:123], v[52:55], v[248:251]
    v_mfma_f32_16x16x32_bf16 v[248:251], v[124:127], v[56:59], v[248:251]
    s_add_u32 s52, s52, 3072
    v_mfma_f32_16x16x32_bf16 v[252:255], v[124:127], v[60:63], v[252:255]
    ds_read_b128 v[48:51], v4 offset:6272
    v_mfma_f32_16x16x32_bf16 v[252:255], v[120:123], v[56:59], v[252:255]
    s_add_u32 s53, s53, 1
    v_mfma_f32_16x16x32_bf16 v[252:255], v[116:119], v[52:55], v[252:255]
    s_branch L_loop
L_last:
    s_waitcnt vmcnt(10)
    v_mfma_f32_16x16x32_bf16 v[160:163], v[92:95], v[16:19], v[160:163]
    v_mfma_f32_16x16x32_bf16 v[160:163], v[96:99], v[20:23], v[160:163]
    v_mfma_f32_16x16x32_bf16 v[160:163], v[100:103], v[24:27], v[160:163]
    ds_write_b128 v7, v[128:131] offset:0
    v_mfma_f32_16x16x32_bf16 v[164:167], v[100:103], v[28:31], v[164:167]
    v_mfma_f32_16x16x32_bf16 v[164:167], v[96:99], v[24:27], v[164:167]
    v_mfma_f32_16x16x32_bf16 v[164:167], v[92:95], v[20:23], v[164:167]
    ds_write_b128 v7, v[132:135] offset:1040
    v_mfma_f32_16x16x32_bf16 v[168:171], v[92:95], v[24:27], v[168:171]
    v_mfma_f32_16x16x32_bf16 v[168:171], v[96:99], v[28:31], v[168:171]
    v_mfma_f32_16x16x32_bf16 v[168:171], v[100:103], v[32:35], v[168:171]
    ds_write_b128 v7, v[136:139] offset:2080
    v_mfma_f32_16x16x32_bf16 v[172:175], v[100:103], v[36:39], v[172:175]
    v_mfma_f32_16x16x32_bf16 v[172:175], v[96:99], v[32:35], v[172:175]
    v_mfma_f32_16x16x32_bf16 v[172:175], v[92:95], v[28:31], v[172:175]
    ds_write_b128 v7, v[140:143] offset:3120
    v_mfma_f32_16x16x32_bf16 v[176:179], v[92:95], v[40:43], v[176:179]
    v_mfma_f32_16x16x32_bf16 v[176:179], v[96:99], v[44:47], v[176:179]
    v_mfma_f32_16x16x32_bf16 v[176:179], v[100:103], v[48:51], v[176:179]
    ds_write_b128 v7, v[144:147] offset:4160
    v_mfma_f32_16x16x32_bf16 v[180:183], v[100:103], v[52:55], v[180:183]
    v_mfma_f32_16x16x32_bf16 v[180:183], v[96:99], v[48:51], v[180:183]
    v_mfma_f32_16x16x32_bf16 v[180:183], v[92:95], v[44:47], v[180:183]
    ds_write_b128 v7, v[148:151] offset:5200
    v_mfma_f32_16x16x32_bf16 v[184:187], v[92:95], v[48:51], v[184:187]
    v_mfma_f32_16x16x32_bf16 v[184:187], v[96:99], v[52:55], v[184:187]
    v_mfma_f32_16x16x32_bf16 v[184:187], v[100:103], v[56:59], v[184:187]
    ds_write_b128 v7, v[152:155] offset:6240
    v_mfma_f32_16x16x32_bf16 v[188:191], v[100:103], v[60:63], v[188:191]
    v_mfma_f32_16x16x32_bf16 v[188:191], v[96:99], v[56:59], v[188:191]
    v_mfma_f32_16x16x32_bf16 v[188:191], v[92:95], v[52:55], v[188:191]
    ds_write_b128 v7, v[156:159] offset:7280
    s_waitcnt vmcnt(7)
    v_mfma_f32_16x16x32_bf16 v[192:195], v[104:107], v[16:19], v[192:195]
    v_mfma_f32_16x16x32_bf16 v[192:195], v[108:111], v[20:23], v[192:195]
    v_mfma_f32_16x16x32_bf16 v[192:195], v[112:115], v[24:27], v[192:195]
    ds_write_b128 v7, v[160:163] offset:8320
    v_mfma_f32_16x16x32_bf16 v[196:199], v[112:115], v[28:31], v[196:199]
    v_mfma_f32_16x16x32_bf16 v[196:199], v[108:111], v[24:27], v[196:199]
    v_mfma_f32_16x16x32_bf16 v[196:199], v[104:107], v[20:23], v[196:199]
    ds_write_b128 v7, v[164:167] offset:9360
    v_mfma_f32_16x16x32_bf16 v[200:203], v[104:107], v[24:27], v[200:203]
    v_mfma_f32_16x16x32_bf16 v[200:203], v[108:111], v[28:31], v[200:203]
    v_mfma_f32_16x16x32_bf16 v[200:203], v[112:115], v[32:35], v[200:203]
    ds_write_b128 v7, v[168:171] offset:10400
    v_mfma_f32_16x16x32_bf16 v[204:207], v[112:115], v[36:39], v[204:207]
    v_mfma_f32_16x16x32_bf16 v[204:207], v[108:111], v[32:35], v[204:207]
    v_mfma_f32_16x16x32_bf16 v[204:207], v[104:107], v[28:31], v[204:207]
    ds_write_b128 v7, v[172:175] offset:11440
    v_mfma_f32_16x16x32_bf16 v[208:211], v[104:107], v[40:43], v[208:211]
    v_mfma_f32_16x16x32_bf16 v[208:211], v[108:111], v[44:47], v[208:211]
    v_mfma_f32_16x16x32_bf16 v[208:211], v[112:115], v[48:51], v[208:211]
    ds_write_b128 v7, v[176:179] offset:12480
    v_mfma_f32_16x16x32_bf16 v[212:215], v[112:115], v[52:55], v[212:215]
    v_mfma_f32_16x16x32_bf16 v[212:215], v[108:111], v[48:51], v[212:215]
    v_mfma_f32_16x16x32_bf16 v[212:215], v[104:107], v[44:47], v[212:215]
    ds_write_b128 v7, v[180:183] offset:13520
    v_mfma_f32_16x16x32_bf16 v[216:219], v[104:107], v[48:51], v[216:219]
    v_mfma_f32_16x16x32_bf16 v[216:219], v[108:111], v[52:55], v[216:219]
    v_mfma_f32_16x16x32_bf16 v[216:219], v[112:115], v[56:59], v[216:219]
    ds_write_b128 v7, v[184:187] offset:14560
    v_mfma_f32_16x16x32_bf16 v[220:223], v[112:115], v[60:63], v[220:223]
    v_mfma_f32_16x16x32_bf16 v[220:223], v[108:111], v[56:59], v[220:223]
    v_mfma_f32_16x16x32_bf16 v[220:223], v[104:107], v[52:55], v[220:223]
    ds_write_b128 v7, v[188:191] offset:15600
    s_waitcnt vmcnt(4)
    v_mfma_f32_16x16x32_bf16 v[224:227], v[116:119], v[16:19], v[224:227]
    v_mfma_f32_16x16x32_bf16 v[224:227], v[120:123], v[20:23], v[224:227]
    v_mfma_f32_16x16x32_bf16 v[224:227], v[124:127], v[24:27], v[224:227]
    ds_write_b128 v7, v[192:195] offset:16640
    v_mfma_f32_16x16x32_bf16 v[228:231], v[124:127], v[28:31], v[228:231]
    v_mfma_f32_16x16x32_bf16 v[228:231], v[120:123], v[24:27], v[228:231]
    v_mfma_f32_16x16x32_bf16 v[228:231], v[116:119], v[20:23], v[228:231]
    ds_write_b128 v7, v[196:199] offset:17680
    v_mfma_f32_16x16x32_bf16 v[232:235], v[116:119], v[24:27], v[232:235]
    v_mfma_f32_16x16x32_bf16 v[232:235], v[120:123], v[28:31], v[232:235]
    v_mfma_f32_16x16x32_bf16 v[232:235], v[124:127], v[32:35], v[232:235]
    ds_write_b128 v7, v[200:203] offset:18720
    v_mfma_f32_16x16x32_bf16 v[236:239], v[124:127], v[36:39], v[236:239]
    v_mfma_f32_16x16x32_bf16 v[236:239], v[120:123], v[32:35], v[236:239]
    v_mfma_f32_16x16x32_bf16 v[236:239], v[116:119], v[28:31], v[236:239]
    ds_write_b128 v7, v[204:207] offset:19760
    v_mfma_f32_16x16x32_bf16 v[240:243], v[116:119], v[40:43], v[240:243]
    ds_write_b128 v7, v[224:227] offset:24960
    v_mfma_f32_16x16x32_bf16 v[240:243], v[120:123], v[44:47], v[240:243]
    v_mfma_f32_16x16x32_bf16 v[240:243], v[124:127], v[48:51], v[240:243]
    ds_write_b128 v7, v[208:211] offset:20800
    v_mfma_f32_16x16x32_bf16 v[244:247], v[124:127], v[52:55], v[244:247]
    ds_write_b128 v7, v[228:231] offset:26000
    v_mfma_f32_16x16x32_bf16 v[244:247], v[120:123], v[48:51], v[244:247]
    v_mfma_f32_16x16x32_bf16 v[244:247], v[116:119], v[44:47], v[244:247]
    ds_write_b128 v7, v[212:215] offset:21840
    v_mfma_f32_16x16x32_bf16 v[248:251], v[116:119], v[48:51], v[248:251]
    ds_write_b128 v7, v[232:235] offset:27040
    v_mfma_f32_16x16x32_bf16 v[248:251], v[120:123], v[52:55], v[248:251]
    v_mfma_f32_16x16x32_bf16 v[248:251], v[124:127], v[56:59], v[248:251]
    ds_write_b128 v7, v[216:219] offset:22880
    v_mfma_f32_16x16x32_bf16 v[252:255], v[124:127], v[60:63], v[252:255]
    ds_write_b128 v7, v[236:239] offset:28080
    v_mfma_f32_16x16x32_bf16 v[252:255], v[120:123], v[56:59], v[252:255]
    v_mfma_f32_16x16x32_bf16 v[252:255], v[116:119], v[52:55], v[252:255]
    ds_write_b128 v7, v[220:223] offset:23920
    ds_write_b128 v7, v[240:243] offset:29120
    ds_write_b128 v7, v[244:247] offset:30160
    s_nop 3
    ds_write_b128 v7, v[248:251] offset:31200
    s_nop 1
    ds_write_b128 v7, v[252:255] offset:32240
    s_waitcnt vmcnt(0)
    s_cmp_lg_u32 s89, 0
    s_cbranch_scc1 L_el_7
    s_mov_b32 s24, s76
    s_mov_b32 s25, s77
    s_mov_b32 s26, 0x400
    s_mov_b32 s27, 0x20000
    s_mov_b32 s28, s78
    s_mov_b32 s29, s79
    s_mov_b32 s30, 0x400
    s_mov_b32 s31, 0x20000
    s_and_b32 s4, s43, 1
    s_lshl_b32 s4, s4, 6
    s_lshl_b32 s3, s40, 7
    s_add_u32 s3, s3, s4
    v_lshlrev_b32 v13, 4, v9
    buffer_load_dwordx4 v[104:107], v13, s[24:27], s3 offen
    buffer_load_dwordx4 v[108:111], v13, s[28:31], s3 offen
    s_branch L_eld_8
L_el_7:
    s_lshl_b32 s3, s41, 22
    s_lshl_b32 s4, s40, 19
    s_add_u32 s3, s3, s4
    s_lshr_b32 s4, s43, 2
    s_lshl_b32 s4, s4, 18
    s_add_u32 s3, s3, s4
    s_bfe_u32 s4, s43, 0x10001
    s_lshl_b32 s4, s4, 15
    s_add_u32 s3, s3, s4
    s_lshl_b32 s4, s42, 9
    s_add_u32 s3, s3, s4
    s_and_b32 s4, s43, 1
    s_lshl_b32 s4, s4, 8
    s_add_u32 s60, s3, s4
    s_add_u32 s61, s60, 8192
    s_add_u32 s62, s60, 16384
    s_add_u32 s63, s60, 24576
    v_lshlrev_b32 v13, 16, v9
    v_lshl_add_u32 v13, v8, 3, v13
L_eld_8:
    s_waitcnt lgkmcnt(0)
    s_branch L_epi
L_prod:
    s_lshl_b32 s4, s41, 22
    s_add_u32 s3, s3, s4
    s_add_u32 s16, s86, s3
    s_addc_u32 s17, s87, 0
    s_mov_b32 s18, 0x400000
    s_mov_b32 s19, 0x20000
    s_sub_u32 s4, s43, 4
    s_lshl_b32 s4, s4, 10
    v_add_u32 v3, s4, v6
    s_cmp_eq_u32 s43, 7
    s_cselect_b32 s4, 0, s4
    s_add_u32 s4, s4, 1088
    s_cmp_eq_u32 s43, 4
    s_cselect_b32 s4, 0, s4
    v_add_u32 v4, s4, v6
    v_add_u32 v5, 66560, v4
    s_lshl_b32 s3, s42, 14
    s_add_u32 s52, s3, 0xfffff000
    s_add_u32 s53, s3, 0x0
    s_add_u32 s54, s3, 0x1000
    s_add_u32 s55, s3, 0x2000
    s_add_u32 s56, s3, 0x3000
    s_add_u32 s57, s3, 0x4000
    s_cmp_eq_u32 s42, 0
    s_cselect_b32 s52, 0x40000000, s52
    s_cmp_eq_u32 s42, 15
    s_cselect_b32 s57, 0x40000000, s57
    s_cmp_lg_u32 s43, 4
    s_cbranch_scc1 L_u2c
    s_sleep 6
    s_mov_b32 s5, 0
L_poll_9:
    buffer_load_dword v25, v23, s[20:23], 0 offen sc0 sc1
    s_waitcnt vmcnt(0)
    v_cmp_ne_u32 vcc, s88, v25
    s_cmp_eq_u64 vcc, 0
    s_cbranch_scc1 L_polld_10
    s_add_u32 s5, s5, 1
    s_cmp_lt_u32 s5, 0x80000
    s_cbranch_scc0 L_polld_10
    s_sleep 1
    s_branch L_poll_9
L_polld_10:
    s_branch L_nopoll
L_u2c:
    s_cmp_lg_u32 s89, 0
    s_cbranch_scc1 L_nopoll
    s_mov_b32 s38, 0
L_pu2:
    s_mov_b32 s5, s38
    s_mul_i32 s3, s5, 9216
    s_add_u32 s3, s3, 133696
    v_mul_u32_u24 v132, 9, v9
    v_lshl_add_u32 v133, v8, 6, s3
    v_add_u32 v134, 0, v132
    v_lshrrev_b32 v135, 2, v134
    v_and_b32 v134, 3, v134
    v_lshl_add_u32 v135, v135, 10, v133
    v_lshl_add_u32 v10, v134, 4, v135
    v_add_u32 v134, 1, v132
    v_lshrrev_b32 v135, 2, v134
    v_and_b32 v134, 3, v134
    v_lshl_add_u32 v135, v135, 10, v133
    v_lshl_add_u32 v11, v134, 4, v135
    v_add_u32 v134, 2, v132
    v_lshrrev_b32 v135, 2, v134
    v_and_b32 v134, 3, v134
    v_lshl_add_u32 v135, v135, 10, v133
    v_lshl_add_u32 v12, v134, 4, v135
    v_add_u32 v134, 3, v132
    v_lshrrev_b32 v135, 2, v134
    v_and_b32 v134, 3, v134
    v_lshl_add_u32 v135, v135, 10, v133
    v_lshl_add_u32 v13, v134, 4, v135
    ds_read_b128 v[96:99], v10 offset:0
    ds_read_b128 v[100:103], v11 offset:0
    ds_read_b128 v[104:107], v12 offset:0
    ds_read_b128 v[108:111], v13 offset:0
    ds_read_b128 v[112:115], v10 offset:1024
    ds_read_b128 v[116:119], v11 offset:1024
    ds_read_b128 v[120:123], v12 offset:1024
    ds_read_b128 v[124:127], v13 offset:1024
    ds_read_b128 v[128:131], v10 offset:2048
    s_lshr_b32 s3, s36, 2
    s_mul_i32 s3, s3, 786432
    s_lshl_b32 s4, s37, 1
    s_add_u32 s4, s4, s5
    s_lshl_b32 s4, s4, 2
    s_and_b32 s5, s36, 3
    s_add_u32 s4, s4, s5
    s_mul_i32 s4, s4, 3
    s_and_b32 s5, s43, 3
    s_add_u32 s4, s4, s5
    s_sub_u32 s4, s4, 1
    s_lshl_b32 s4, s4, 10
    s_add_u32 s39, s3, s4
    s_mov_b32 s6, 0x07060100
    s_mov_b32 s7, 0x05040302
    s_waitcnt lgkmcnt(0)
    s_cmp_eq_u32 s5, 2
    s_cbranch_scc1 L_wp_12
    s_cmp_eq_u32 s5, 3
    s_cbranch_scc1 L_wp_13
L_wp_11:
    v_perm_b32 v142, v100, v96, s6
    v_perm_b32 v143, v109, v105, s6
    v_perm_b32 v144, v118, v114, s6
    v_perm_b32 v145, v127, v123, s6
    v_perm_b32 v154, v103, v99, s6
    v_perm_b32 v155, v112, v108, s6
    v_perm_b32 v156, v121, v117, s6
    v_perm_b32 v157, v130, v126, s6
    v_lshlrev_b32 v132, 16, v96
    v_and_b32 v133, 0xffff0000, v97
    v_lshlrev_b32 v134, 16, v99
    v_and_b32 v135, 0xffff0000, v100
    v_lshlrev_b32 v136, 16, v102
    v_and_b32 v137, 0xffff0000, v103
    v_add_f32 v132, v132, v134
    v_add_f32 v135, v135, v137
    v_add_f32 v138, v132, v133
    v_sub_f32 v140, v132, v133
    v_add_f32 v139, v135, v136
    v_sub_f32 v141, v135, v136
    v_cvt_pk_bf16_f32 v146, v138, v139
    v_cvt_pk_bf16_f32 v150, v140, v141
    v_lshlrev_b32 v132, 16, v105
    v_and_b32 v133, 0xffff0000, v106
    v_lshlrev_b32 v134, 16, v108
    v_and_b32 v135, 0xffff0000, v109
    v_lshlrev_b32 v136, 16, v111
    v_and_b32 v137, 0xffff0000, v112
    v_add_f32 v132, v132, v134
    v_add_f32 v135, v135, v137
    v_add_f32 v138, v132, v133
    v_sub_f32 v140, v132, v133
    v_add_f32 v139, v135, v136
    v_sub_f32 v141, v135, v136
    v_cvt_pk_bf16_f32 v147, v138, v139
    v_cvt_pk_bf16_f32 v151, v140, v141
    v_lshlrev_b32 v132, 16, v114
    v_and_b32 v133, 0xffff0000, v115
    v_lshlrev_b32 v134, 16, v117
    v_and_b32 v135, 0xffff0000, v118
    v_lshlrev_b32 v136, 16, v120
    v_and_b32 v137, 0xffff0000, v121
    v_add_f32 v132, v132, v134
    v_add_f32 v135, v135, v137
    v_add_f32 v138, v132, v133
    v_sub_f32 v140, v132, v133
    v_add_f32 v139, v135, v136
    v_sub_f32 v141, v135, v136
    v_cvt_pk_bf16_f32 v148, v138, v139
    v_cvt_pk_bf16_f32 v152, v140, v141
    v_lshlrev_b32 v132, 16, v123
    v_and_b32 v133, 0xffff0000, v124
    v_lshlrev_b32 v134, 16, v126
    v_and_b32 v135, 0xffff0000, v127
    v_lshlrev_b32 v136, 16, v129
    v_and_b32 v137, 0xffff0000, v130
    v_add_f32 v132, v132, v134
    v_add_f32 v135, v135, v137
    v_add_f32 v138, v132, v133
    v_sub_f32 v140, v132, v133
    v_add_f32 v139, v135, v136
    v_sub_f32 v141, v135, v136
    v_cvt_pk_bf16_f32 v149, v138, v139
    v_cvt_pk_bf16_f32 v153, v140, v141
    s_branch L_wp_14
L_wp_12:
    v_perm_b32 v142, v101, v96, s7
    v_perm_b32 v143, v110, v105, s7
    v_perm_b32 v144, v119, v114, s7
    v_perm_b32 v145, v128, v123, s7
    v_perm_b32 v154, v104, v99, s7
    v_perm_b32 v155, v113, v108, s7
    v_perm_b32 v156, v122, v117, s7
    v_perm_b32 v157, v131, v126, s7
    v_and_b32 v132, 0xffff0000, v96
    v_lshlrev_b32 v133, 16, v98
    v_and_b32 v134, 0xffff0000, v99
    v_lshlrev_b32 v135, 16, v101
    v_and_b32 v136, 0xffff0000, v102
    v_lshlrev_b32 v137, 16, v104
    v_add_f32 v132, v132, v134
    v_add_f32 v135, v135, v137
    v_add_f32 v138, v132, v133
    v_sub_f32 v140, v132, v133
    v_add_f32 v139, v135, v136
    v_sub_f32 v141, v135, v136
    v_cvt_pk_bf16_f32 v146, v138, v139
    v_cvt_pk_bf16_f32 v150, v140, v141
    v_and_b32 v132, 0xffff0000, v105
    v_lshlrev_b32 v133, 16, v107
    v_and_b32 v134, 0xffff0000, v108
    v_lshlrev_b32 v135, 16, v110
    v_and_b32 v136, 0xffff0000, v111
    v_lshlrev_b32 v137, 16, v113
    v_add_f32 v132, v132, v134
    v_add_f32 v135, v135, v137
    v_add_f32 v138, v132, v133
    v_sub_f32 v140, v132, v133
    v_add_f32 v139, v135, v136
    v_sub_f32 v141, v135, v136
    v_cvt_pk_bf16_f32 v147, v138, v139
    v_cvt_pk_bf16_f32 v151, v140, v141
    v_and_b32 v132, 0xffff0000, v114
    v_lshlrev_b32 v133, 16, v116
    v_and_b32 v134, 0xffff0000, v117
    v_lshlrev_b32 v135, 16, v119
    v_and_b32 v136, 0xffff0000, v120
    v_lshlrev_b32 v137, 16, v122
    v_add_f32 v132, v132, v134
    v_add_f32 v135, v135, v137
    v_add_f32 v138, v132, v133
    v_sub_f32 v140, v132, v133
    v_add_f32 v139, v135, v136
    v_sub_f32 v141, v135, v136
    v_cvt_pk_bf16_f32 v148, v138, v139
    v_cvt_pk_bf16_f32 v152, v140, v141
    v_and_b32 v132, 0xffff0000, v123
    v_lshlrev_b32 v133, 16, v125
    v_and_b32 v134, 0xffff0000, v126
    v_lshlrev_b32 v135, 16, v128
    v_and_b32 v136, 0xffff0000, v129
    v_lshlrev_b32 v137, 16, v131
    v_add_f32 v132, v132, v134
    v_add_f32 v135, v135, v137
    v_add_f32 v138, v132, v133
    v_sub_f32 v140, v132, v133
    v_add_f32 v139, v135, v136
    v_sub_f32 v141, v135, v136
    v_cvt_pk_bf16_f32 v149, v138, v139
    v_cvt_pk_bf16_f32 v153, v140, v141
    s_branch L_wp_14
L_wp_13:
    v_perm_b32 v142, v101, v97, s6
    v_perm_b32 v143, v110, v106, s6
    v_perm_b32 v144, v119, v115, s6
    v_perm_b32 v145, v128, v124, s6
    v_perm_b32 v154, v104, v100, s6
    v_perm_b32 v155, v113, v109, s6
    v_perm_b32 v156, v122, v118, s6
    v_perm_b32 v157, v131, v127, s6
    v_lshlrev_b32 v132, 16, v97
    v_and_b32 v133, 0xffff0000, v98
    v_lshlrev_b32 v134, 16, v100
    v_and_b32 v135, 0xffff0000, v101
    v_lshlrev_b32 v136, 16, v103
    v_and_b32 v137, 0xffff0000, v104
    v_add_f32 v132, v132, v134
    v_add_f32 v135, v135, v137
    v_add_f32 v138, v132, v133
    v_sub_f32 v140, v132, v133
    v_add_f32 v139, v135, v136
    v_sub_f32 v141, v135, v136
    v_cvt_pk_bf16_f32 v146, v138, v139
    v_cvt_pk_bf16_f32 v150, v140, v141
    v_lshlrev_b32 v132, 16, v106
    v_and_b32 v133, 0xffff0000, v107
    v_lshlrev_b32 v134, 16, v109
    v_and_b32 v135, 0xffff0000, v110
    v_lshlrev_b32 v136, 16, v112
    v_and_b32 v137, 0xffff0000, v113
    v_add_f32 v132, v132, v134
    v_add_f32 v135, v135, v137
    v_add_f32 v138, v132, v133
    v_sub_f32 v140, v132, v133
    v_add_f32 v139, v135, v136
    v_sub_f32 v141, v135, v136
    v_cvt_pk_bf16_f32 v147, v138, v139
    v_cvt_pk_bf16_f32 v151, v140, v141
    v_lshlrev_b32 v132, 16, v115
    v_and_b32 v133, 0xffff0000, v116
    v_lshlrev_b32 v134, 16, v118
    v_and_b32 v135, 0xffff0000, v119
    v_lshlrev_b32 v136, 16, v121
    v_and_b32 v137, 0xffff0000, v122
    v_add_f32 v132, v132, v134
    v_add_f32 v135, v135, v137
    v_add_f32 v138, v132, v133
    v_sub_f32 v140, v132, v133
    v_add_f32 v139, v135, v136
    v_sub_f32 v141, v135, v136
    v_cvt_pk_bf16_f32 v148, v138, v139
    v_cvt_pk_bf16_f32 v152, v140, v141
    v_lshlrev_b32 v132, 16, v124
    v_and_b32 v133, 0xffff0000, v125
    v_lshlrev_b32 v134, 16, v127
    v_and_b32 v135, 0xffff0000, v128
    v_lshlrev_b32 v136, 16, v130
    v_and_b32 v137, 0xffff0000, v131
    v_add_f32 v132, v132, v134
    v_add_f32 v135, v135, v137
    v_add_f32 v138, v132, v133
    v_sub_f32 v140, v132, v133
    v_add_f32 v139, v135, v136
    v_sub_f32 v141, v135, v136
    v_cvt_pk_bf16_f32 v149, v138, v139
    v_cvt_pk_bf16_f32 v153, v140, v141
L_wp_14:
    s_cmp_lg_u32 s38, 0
    s_cbranch_scc1 L_pu2d
    s_mov_b32 s60, s39
    v_mov_b32 v160, v142
    v_mov_b32 v161, v143
    v_mov_b32 v162, v144
    v_mov_b32 v163, v145
    v_mov_b32 v164, v146
    v_mov_b32 v165, v147
    v_mov_b32 v166, v148
    v_mov_b32 v167, v149
    v_mov_b32 v168, v150
    v_mov_b32 v169, v151
    v_mov_b32 v170, v152
    v_mov_b32 v171, v153
    v_mov_b32 v172, v154
    v_mov_b32 v173, v155
    v_mov_b32 v174, v156
    v_mov_b32 v175, v157
    s_mov_b32 s38, 1
    s_branch L_pu2
L_pu2d:
    s_mov_b32 s61, s39
L_nopoll:
    s_barrier
    buffer_load_dwordx4 v[24:27], v3, s[16:19], s52 offen sc0 sc1
    buffer_load_dwordx4 v[28:31], v3, s[16:19], s53 offen sc0 sc1
    buffer_load_dwordx4 v[32:35], v3, s[16:19], s54 offen sc0 sc1
    buffer_load_dwordx4 v[36:39], v3, s[16:19], s55 offen sc0 sc1
    buffer_load_dwordx4 v[40:43], v3, s[16:19], s56 offen sc0 sc1
    buffer_load_dwordx4 v[44:47], v3, s[16:19], s57 offen sc0 sc1
    v_add_u32 v3, 0x40000, v3
    buffer_load_dwordx4 v[48:51], v3, s[16:19], s52 offen sc0 sc1
    buffer_load_dwordx4 v[52:55], v3, s[16:19], s53 offen sc0 sc1
    buffer_load_dwordx4 v[56:59], v3, s[16:19], s54 offen sc0 sc1
    buffer_load_dwordx4 v[60:63], v3, s[16:19], s55 offen sc0 sc1
    buffer_load_dwordx4 v[64:67], v3, s[16:19], s56 offen sc0 sc1
    buffer_load_dwordx4 v[68:71], v3, s[16:19], s57 offen sc0 sc1
    v_add_u32 v3, 0x40000, v3
    s_mov_b32 s58, 0
L_ploop:
    s_waitcnt vmcnt(6)
    v_fma_mix_f32 v176, v24, 1.0, -v32 op_sel:[0,0,0] op_sel_hi:[1,0,1]
    v_fma_mix_f32 v177, v24, 1.0, -v32 op_sel:[1,0,1] op_sel_hi:[1,0,1]
    v_fma_mix_f32 v178, v25, 1.0, -v33 op_sel:[0,0,0] op_sel_hi:[1,0,1]
    v_fma_mix_f32 v179, v25, 1.0, -v33 op_sel:[1,0,1] op_sel_hi:[1,0,1]
    buffer_load_dwordx4 v[72:75], v3, s[16:19], s52 offen sc0 sc1
    v_fma_mix_f32 v180, v26, 1.0, -v34 op_sel:[0,0,0] op_sel_hi:[1,0,1]
    v_fma_mix_f32 v181, v26, 1.0, -v34 op_sel:[1,0,1] op_sel_hi:[1,0,1]
    v_fma_mix_f32 v182, v27, 1.0, -v35 op_sel:[0,0,0] op_sel_hi:[1,0,1]
    v_fma_mix_f32 v183, v27, 1.0, -v35 op_sel:[1,0,1] op_sel_hi:[1,0,1]
    v_cvt_pk_bf16_f32 v120, v176, v177
    v_cvt_pk_bf16_f32 v121, v178, v179
    v_cvt_pk_bf16_f32 v122, v180, v181
    v_cvt_pk_bf16_f32 v123, v182, v183
    ds_write_b128 v4, v[120:123] offset:0
    v_fma_mix_f32 v184, v28, 1.0, v32 op_sel:[0,0,0] op_sel_hi:[1,0,1]
    v_fma_mix_f32 v185, v28, 1.0, v32 op_sel:[1,0,1] op_sel_hi:[1,0,1]
    v_fma_mix_f32 v186, v29, 1.0, v33 op_sel:[0,0,0] op_sel_hi:[1,0,1]
    v_fma_mix_f32 v187, v29, 1.0, v33 op_sel:[1,0,1] op_sel_hi:[1,0,1]
    buffer_load_dwordx4 v[76:79], v3, s[16:19], s53 offen sc0 sc1
    v_fma_mix_f32 v188, v30, 1.0, v34 op_sel:[0,0,0] op_sel_hi:[1,0,1]
    v_fma_mix_f32 v189, v30, 1.0, v34 op_sel:[1,0,1] op_sel_hi:[1,0,1]
    v_fma_mix_f32 v190, v31, 1.0, v35 op_sel:[0,0,0] op_sel_hi:[1,0,1]
    v_fma_mix_f32 v191, v31, 1.0, v35 op_sel:[1,0,1] op_sel_hi:[1,0,1]
    v_cvt_pk_bf16_f32 v124, v184, v185
    v_cvt_pk_bf16_f32 v125, v186, v187
    v_cvt_pk_bf16_f32 v126, v188, v189
    v_cvt_pk_bf16_f32 v127, v190, v191
    ds_write_b128 v4, v[124:127] offset:33280
    v_fma_mix_f32 v176, v32, 1.0, -v28 op_sel:[0,0,0] op_sel_hi:[1,0,1]
    v_fma_mix_f32 v177, v32, 1.0, -v28 op_sel:[1,0,1] op_sel_hi:[1,0,1]
    v_fma_mix_f32 v178, v33, 1.0, -v29 op_sel:[0,0,0] op_sel_hi:[1,0,1]
    v_fma_mix_f32 v179, v33, 1.0, -v29 op_sel:[1,0,1] op_sel_hi:[1,0,1]
    buffer_load_dwordx4 v[80:83], v3, s[16:19], s54 offen sc0 sc1
    v_fma_mix_f32 v180, v34, 1.0, -v30 op_sel:[0,0,0] op_sel_hi:[1,0,1]
    v_fma_mix_f32 v181, v34, 1.0, -v30 op_sel:[1,0,1] op_sel_hi:[1,0,1]
    v_fma_mix_f32 v182, v35, 1.0, -v31 op_sel:[0,0,0] op_sel_hi:[1,0,1]
    v_fma_mix_f32 v183, v35, 1.0, -v31 op_sel:[1,0,1] op_sel_hi:[1,0,1]
    v_cvt_pk_bf16_f32 v128, v176, v177
    v_cvt_pk_bf16_f32 v129, v178, v179
    v_cvt_pk_bf16_f32 v130, v180, v181
    v_cvt_pk_bf16_f32 v131, v182, v183
    ds_write_b128 v5, v[128:131] offset:0
    v_fma_mix_f32 v184, v28, 1.0, -v36 op_sel:[0,0,0] op_sel_hi:[1,0,1]
    v_fma_mix_f32 v185, v28, 1.0, -v36 op_sel:[1,0,1] op_sel_hi:[1,0,1]
    v_fma_mix_f32 v186, v29, 1.0, -v37 op_sel:[0,0,0] op_sel_hi:[1,0,1]
    v_fma_mix_f32 v187, v29, 1.0, -v37 op_sel:[1,0,1] op_sel_hi:[1,0,1]
    v_fma_mix_f32 v188, v30, 1.0, -v38 op_sel:[0,0,0] op_sel_hi:[1,0,1]
    v_fma_mix_f32 v189, v30, 1.0, -v38 op_sel:[1,0,1] op_sel_hi:[1,0,1]
    v_fma_mix_f32 v190, v31, 1.0, -v39 op_sel:[0,0,0] op_sel_hi:[1,0,1]
    v_fma_mix_f32 v191, v31, 1.0, -v39 op_sel:[1,0,1] op_sel_hi:[1,0,1]
    v_cvt_pk_bf16_f32 v132, v184, v185
    v_cvt_pk_bf16_f32 v133, v186, v187
    v_cvt_pk_bf16_f32 v134, v188, v189
    v_cvt_pk_bf16_f32 v135, v190, v191
    ds_write_b128 v5, v[132:135] offset:33280
    v_fma_mix_f32 v176, v32, 1.0, -v40 op_sel:[0,0,0] op_sel_hi:[1,0,1]
    v_fma_mix_f32 v177, v32, 1.0, -v40 op_sel:[1,0,1] op_sel_hi:[1,0,1]
    v_fma_mix_f32 v178, v33, 1.0, -v41 op_sel:[0,0,0] op_sel_hi:[1,0,1]
    v_fma_mix_f32 v179, v33, 1.0, -v41 op_sel:[1,0,1] op_sel_hi:[1,0,1]
    buffer_load_dwordx4 v[84:87], v3, s[16:19], s55 offen sc0 sc1
    v_fma_mix_f32 v180, v34, 1.0, -v42 op_sel:[0,0,0] op_sel_hi:[1,0,1]
    v_fma_mix_f32 v181, v34, 1.0, -v42 op_sel:[1,0,1] op_sel_hi:[1,0,1]
    v_fma_mix_f32 v182, v35, 1.0, -v43 op_sel:[0,0,0] op_sel_hi:[1,0,1]
    v_fma_mix_f32 v183, v35, 1.0, -v43 op_sel:[1,0,1] op_sel_hi:[1,0,1]
    v_cvt_pk_bf16_f32 v120, v176, v177
    v_cvt_pk_bf16_f32 v121, v178, v179
    v_cvt_pk_bf16_f32 v122, v180, v181
    v_cvt_pk_bf16_f32 v123, v182, v183
    ds_write_b128 v4, v[120:123] offset:4160
    v_fma_mix_f32 v184, v36, 1.0, v40 op_sel:[0,0,0] op_sel_hi:[1,0,1]
    v_fma_mix_f32 v185, v36, 1.0, v40 op_sel:[1,0,1] op_sel_hi:[1,0,1]
    v_fma_mix_f32 v186, v37, 1.0, v41 op_sel:[0,0,0] op_sel_hi:[1,0,1]
    v_fma_mix_f32 v187, v37, 1.0, v41 op_sel:[1,0,1] op_sel_hi:[1,0,1]
    buffer_load_dwordx4 v[88:91], v3, s[16:19], s56 offen sc0 sc1
    v_fma_mix_f32 v188, v38, 1.0, v42 op_sel:[0,0,0] op_sel_hi:[1,0,1]
    v_fma_mix_f32 v189, v38, 1.0, v42 op_sel:[1,0,1] op_sel_hi:[1,0,1]
    v_fma_mix_f32 v190, v39, 1.0, v43 op_sel:[0,0,0] op_sel_hi:[1,0,1]
    v_fma_mix_f32 v191, v39, 1.0, v43 op_sel:[1,0,1] op_sel_hi:[1,0,1]
    v_cvt_pk_bf16_f32 v124, v184, v185
    v_cvt_pk_bf16_f32 v125, v186, v187
    v_cvt_pk_bf16_f32 v126, v188, v189
    v_cvt_pk_bf16_f32 v127, v190, v191
    ds_write_b128 v4, v[124:127] offset:37440
    v_fma_mix_f32 v176, v40, 1.0, -v36 op_sel:[0,0,0] op_sel_hi:[1,0,1]
    v_fma_mix_f32 v177, v40, 1.0, -v36 op_sel:[1,0,1] op_sel_hi:[1,0,1]
    v_fma_mix_f32 v178, v41, 1.0, -v37 op_sel:[0,0,0] op_sel_hi:[1,0,1]
    v_fma_mix_f32 v179, v41, 1.0, -v37 op_sel:[1,0,1] op_sel_hi:[1,0,1]
    buffer_load_dwordx4 v[92:95], v3, s[16:19], s57 offen sc0 sc1
    v_fma_mix_f32 v180, v42, 1.0, -v38 op_sel:[0,0,0] op_sel_hi:[1,0,1]
    v_fma_mix_f32 v181, v42, 1.0, -v38 op_sel:[1,0,1] op_sel_hi:[1,0,1]
    v_fma_mix_f32 v182, v43, 1.0, -v39 op_sel:[0,0,0] op_sel_hi:[1,0,1]
    v_fma_mix_f32 v183, v43, 1.0, -v39 op_sel:[1,0,1] op_sel_hi:[1,0,1]
    v_cvt_pk_bf16_f32 v128, v176, v177
    v_cvt_pk_bf16_f32 v129, v178, v179
    v_cvt_pk_bf16_f32 v130, v180, v181
    v_cvt_pk_bf16_f32 v131, v182, v183
    ds_write_b128 v5, v[128:131] offset:4160
    v_fma_mix_f32 v184, v36, 1.0, -v44 op_sel:[0,0,0] op_sel_hi:[1,0,1]
    v_fma_mix_f32 v185, v36, 1.0, -v44 op_sel:[1,0,1] op_sel_hi:[1,0,1]
    v_fma_mix_f32 v186, v37, 1.0, -v45 op_sel:[0,0,0] op_sel_hi:[1,0,1]
    v_fma_mix_f32 v187, v37, 1.0, -v45 op_sel:[1,0,1] op_sel_hi:[1,0,1]
    v_fma_mix_f32 v188, v38, 1.0, -v46 op_sel:[0,0,0] op_sel_hi:[1,0,1]
    v_fma_mix_f32 v189, v38, 1.0, -v46 op_sel:[1,0,1] op_sel_hi:[1,0,1]
    v_fma_mix_f32 v190, v39, 1.0, -v47 op_sel:[0,0,0] op_sel_hi:[1,0,1]
    v_fma_mix_f32 v191, v39, 1.0, -v47 op_sel:[1,0,1] op_sel_hi:[1,0,1]
    v_cvt_pk_bf16_f32 v132, v184, v185
    v_cvt_pk_bf16_f32 v133, v186, v187
    v_cvt_pk_bf16_f32 v134, v188, v189
    v_cvt_pk_bf16_f32 v135, v190, v191
    ds_write_b128 v5, v[132:135] offset:37440
    v_add_u32 v3, 0x40000, v3
    s_waitcnt lgkmcnt(0)
    s_barrier
    s_waitcnt vmcnt(6)
    v_fma_mix_f32 v176, v48, 1.0, -v56 op_sel:[0,0,0] op_sel_hi:[1,0,1]
    v_fma_mix_f32 v177, v48, 1.0, -v56 op_sel:[1,0,1] op_sel_hi:[1,0,1]
    v_fma_mix_f32 v178, v49, 1.0, -v57 op_sel:[0,0,0] op_sel_hi:[1,0,1]
    v_fma_mix_f32 v179, v49, 1.0, -v57 op_sel:[1,0,1] op_sel_hi:[1,0,1]
    buffer_load_dwordx4 v[96:99], v3, s[16:19], s52 offen sc0 sc1
    v_fma_mix_f32 v180, v50, 1.0, -v58 op_sel:[0,0,0] op_sel_hi:[1,0,1]
    v_fma_mix_f32 v181, v50, 1.0, -v58 op_sel:[1,0,1] op_sel_hi:[1,0,1]
    v_fma_mix_f32 v182, v51, 1.0, -v59 op_sel:[0,0,0] op_sel_hi:[1,0,1]
    v_fma_mix_f32 v183, v51, 1.0, -v59 op_sel:[1,0,1] op_sel_hi:[1,0,1]
    v_cvt_pk_bf16_f32 v120, v176, v177
    v_cvt_pk_bf16_f32 v121, v178, v179
    v_cvt_pk_bf16_f32 v122, v180, v181
    v_cvt_pk_bf16_f32 v123, v182, v183
    ds_write_b128 v4, v[120:123] offset:8320
    v_fma_mix_f32 v184, v52, 1.0, v56 op_sel:[0,0,0] op_sel_hi:[1,0,1]
    v_fma_mix_f32 v185, v52, 1.0, v56 op_sel:[1,0,1] op_sel_hi:[1,0,1]
    v_fma_mix_f32 v186, v53, 1.0, v57 op_sel:[0,0,0] op_sel_hi:[1,0,1]
    v_fma_mix_f32 v187, v53, 1.0, v57 op_sel:[1,0,1] op_sel_hi:[1,0,1]
    buffer_load_dwordx4 v[100:103], v3, s[16:19], s53 offen sc0 sc1
    v_fma_mix_f32 v188, v54, 1.0, v58 op_sel:[0,0,0] op_sel_hi:[1,0,1]
    v_fma_mix_f32 v189, v54, 1.0, v58 op_sel:[1,0,1] op_sel_hi:[1,0,1]
    v_fma_mix_f32 v190, v55, 1.0, v59 op_sel:[0,0,0] op_sel_hi:[1,0,1]
    v_fma_mix_f32 v191, v55, 1.0, v59 op_sel:[1,0,1] op_sel_hi:[1,0,1]
    v_cvt_pk_bf16_f32 v124, v184, v185
    v_cvt_pk_bf16_f32 v125, v186, v187
    v_cvt_pk_bf16_f32 v126, v188, v189
    v_cvt_pk_bf16_f32 v127, v190, v191
    ds_write_b128 v4, v[124:127] offset:41600
    v_fma_mix_f32 v176, v56, 1.0, -v52 op_sel:[0,0,0] op_sel_hi:[1,0,1]
    v_fma_mix_f32 v177, v56, 1.0, -v52 op_sel:[1,0,1] op_sel_hi:[1,0,1]
    v_fma_mix_f32 v178, v57, 1.0, -v53 op_sel:[0,0,0] op_sel_hi:[1,0,1]
    v_fma_mix_f32 v179, v57, 1.0, -v53 op_sel:[1,0,1] op_sel_hi:[1,0,1]
    buffer_load_dwordx4 v[104:107], v3, s[16:19], s54 offen sc0 sc1
    v_fma_mix_f32 v180, v58, 1.0, -v54 op_sel:[0,0,0] op_sel_hi:[1,0,1]
    v_fma_mix_f32 v181, v58, 1.0, -v54 op_sel:[1,0,1] op_sel_hi:[1,0,1]
    v_fma_mix_f32 v182, v59, 1.0, -v55 op_sel:[0,0,0] op_sel_hi:[1,0,1]
    v_fma_mix_f32 v183, v59, 1.0, -v55 op_sel:[1,0,1] op_sel_hi:[1,0,1]
    v_cvt_pk_bf16_f32 v128, v176, v177
    v_cvt_pk_bf16_f32 v129, v178, v179
    v_cvt_pk_bf16_f32 v130, v180, v181
    v_cvt_pk_bf16_f32 v131, v182, v183
    ds_write_b128 v5, v[128:131] offset:8320
    v_fma_mix_f32 v184, v52, 1.0, -v60 op_sel:[0,0,0] op_sel_hi:[1,0,1]
    v_fma_mix_f32 v185, v52, 1.0, -v60 op_sel:[1,0,1] op_sel_hi:[1,0,1]
    v_fma_mix_f32 v186, v53, 1.0, -v61 op_sel:[0,0,0] op_sel_hi:[1,0,1]
    v_fma_mix_f32 v187, v53, 1.0, -v61 op_sel:[1,0,1] op_sel_hi:[1,0,1]
    v_fma_mix_f32 v188, v54, 1.0, -v62 op_sel:[0,0,0] op_sel_hi:[1,0,1]
    v_fma_mix_f32 v189, v54, 1.0, -v62 op_sel:[1,0,1] op_sel_hi:[1,0,1]
    v_fma_mix_f32 v190, v55, 1.0, -v63 op_sel:[0,0,0] op_sel_hi:[1,0,1]
    v_fma_mix_f32 v191, v55, 1.0, -v63 op_sel:[1,0,1] op_sel_hi:[1,0,1]
    v_cvt_pk_bf16_f32 v132, v184, v185
    v_cvt_pk_bf16_f32 v133, v186, v187
    v_cvt_pk_bf16_f32 v134, v188, v189
    v_cvt_pk_bf16_f32 v135, v190, v191
    ds_write_b128 v5, v[132:135] offset:41600
    v_fma_mix_f32 v176, v56, 1.0, -v64 op_sel:[0,0,0] op_sel_hi:[1,0,1]
    v_fma_mix_f32 v177, v56, 1.0, -v64 op_sel:[1,0,1] op_sel_hi:[1,0,1]
    v_fma_mix_f32 v178, v57, 1.0, -v65 op_sel:[0,0,0] op_sel_hi:[1,0,1]
    v_fma_mix_f32 v179, v57, 1.0, -v65 op_sel:[1,0,1] op_sel_hi:[1,0,1]
    buffer_load_dwordx4 v[108:111], v3, s[16:19], s55 offen sc0 sc1
    v_fma_mix_f32 v180, v58, 1.0, -v66 op_sel:[0,0,0] op_sel_hi:[1,0,1]
    v_fma_mix_f32 v181, v58, 1.0, -v66 op_sel:[1,0,1] op_sel_hi:[1,0,1]
    v_fma_mix_f32 v182, v59, 1.0, -v67 op_sel:[0,0,0] op_sel_hi:[1,0,1]
    v_fma_mix_f32 v183, v59, 1.0, -v67 op_sel:[1,0,1] op_sel_hi:[1,0,1]
    v_cvt_pk_bf16_f32 v120, v176, v177
    v_cvt_pk_bf16_f32 v121, v178, v179
    v_cvt_pk_bf16_f32 v122, v180, v181
    v_cvt_pk_bf16_f32 v123, v182, v183
    ds_write_b128 v4, v[120:123] offset:12480
    v_fma_mix_f32 v184, v60, 1.0, v64 op_sel:[0,0,0] op_sel_hi:[1,0,1]
    v_fma_mix_f32 v185, v60, 1.0, v64 op_sel:[1,0,1] op_sel_hi:[1,0,1]
    v_fma_mix_f32 v186, v61, 1.0, v65 op_sel:[0,0,0] op_sel_hi:[1,0,1]
    v_fma_mix_f32 v187, v61, 1.0, v65 op_sel:[1,0,1] op_sel_hi:[1,0,1]
    buffer_load_dwordx4 v[112:115], v3, s[16:19], s56 offen sc0 sc1
    v_fma_mix_f32 v188, v62, 1.0, v66 op_sel:[0,0,0] op_sel_hi:[1,0,1]
    v_fma_mix_f32 v189, v62, 1.0, v66 op_sel:[1,0,1] op_sel_hi:[1,0,1]
    v_fma_mix_f32 v190, v63, 1.0, v67 op_sel:[0,0,0] op_sel_hi:[1,0,1]
    v_fma_mix_f32 v191, v63, 1.0, v67 op_sel:[1,0,1] op_sel_hi:[1,0,1]
    v_cvt_pk_bf16_f32 v124, v184, v185
    v_cvt_pk_bf16_f32 v125, v186, v187
    v_cvt_pk_bf16_f32 v126, v188, v189
    v_cvt_pk_bf16_f32 v127, v190, v191
    ds_write_b128 v4, v[124:127] offset:45760
    v_fma_mix_f32 v176, v64, 1.0, -v60 op_sel:[0,0,0] op_sel_hi:[1,0,1]
    v_fma_mix_f32 v177, v64, 1.0, -v60 op_sel:[1,0,1] op_sel_hi:[1,0,1]
    v_fma_mix_f32 v178, v65, 1.0, -v61 op_sel:[0,0,0] op_sel_hi:[1,0,1]
    v_fma_mix_f32 v179, v65, 1.0, -v61 op_sel:[1,0,1] op_sel_hi:[1,0,1]
    buffer_load_dwordx4 v[116:119], v3, s[16:19], s57 offen sc0 sc1
    v_fma_mix_f32 v180, v66, 1.0, -v62 op_sel:[0,0,0] op_sel_hi:[1,0,1]
    v_fma_mix_f32 v181, v66, 1.0, -v62 op_sel:[1,0,1] op_sel_hi:[1,0,1]
    v_fma_mix_f32 v182, v67, 1.0, -v63 op_sel:[0,0,0] op_sel_hi:[1,0,1]
    v_fma_mix_f32 v183, v67, 1.0, -v63 op_sel:[1,0,1] op_sel_hi:[1,0,1]
    v_cvt_pk_bf16_f32 v128, v176, v177
    v_cvt_pk_bf16_f32 v129, v178, v179
    v_cvt_pk_bf16_f32 v130, v180, v181
    v_cvt_pk_bf16_f32 v131, v182, v183
    ds_write_b128 v5, v[128:131] offset:12480
    v_fma_mix_f32 v184, v60, 1.0, -v68 op_sel:[0,0,0] op_sel_hi:[1,0,1]
    v_fma_mix_f32 v185, v60, 1.0, -v68 op_sel:[1,0,1] op_sel_hi:[1,0,1]
    v_fma_mix_f32 v186, v61, 1.0, -v69 op_sel:[0,0,0] op_sel_hi:[1,0,1]
    v_fma_mix_f32 v187, v61, 1.0, -v69 op_sel:[1,0,1] op_sel_hi:[1,0,1]
    v_fma_mix_f32 v188, v62, 1.0, -v70 op_sel:[0,0,0] op_sel_hi:[1,0,1]
    v_fma_mix_f32 v189, v62, 1.0, -v70 op_sel:[1,0,1] op_sel_hi:[1,0,1]
    v_fma_mix_f32 v190, v63, 1.0, -v71 op_sel:[0,0,0] op_sel_hi:[1,0,1]
    v_fma_mix_f32 v191, v63, 1.0, -v71 op_sel:[1,0,1] op_sel_hi:[1,0,1]
    v_cvt_pk_bf16_f32 v132, v184, v185
    v_cvt_pk_bf16_f32 v133, v186, v187
    v_cvt_pk_bf16_f32 v134, v188, v189
    v_cvt_pk_bf16_f32 v135, v190, v191
    ds_write_b128 v5, v[132:135] offset:45760
    v_add_u32 v3, 0x40000, v3
    s_waitcnt lgkmcnt(0)
    s_barrier
    s_waitcnt vmcnt(6)
    v_fma_mix_f32 v176, v72, 1.0, -v80 op_sel:[0,0,0] op_sel_hi:[1,0,1]
    v_fma_mix_f32 v177, v72, 1.0, -v80 op_sel:[1,0,1] op_sel_hi:[1,0,1]
    v_fma_mix_f32 v178, v73, 1.0, -v81 op_sel:[0,0,0] op_sel_hi:[1,0,1]
    v_fma_mix_f32 v179, v73, 1.0, -v81 op_sel:[1,0,1] op_sel_hi:[1,0,1]
    buffer_load_dwordx4 v[24:27], v3, s[16:19], s52 offen sc0 sc1
    v_fma_mix_f32 v180, v74, 1.0, -v82 op_sel:[0,0,0] op_sel_hi:[1,0,1]
    v_fma_mix_f32 v181, v74, 1.0, -v82 op_sel:[1,0,1] op_sel_hi:[1,0,1]
    v_fma_mix_f32 v182, v75, 1.0, -v83 op_sel:[0,0,0] op_sel_hi:[1,0,1]
    v_fma_mix_f32 v183, v75, 1.0, -v83 op_sel:[1,0,1] op_sel_hi:[1,0,1]
    v_cvt_pk_bf16_f32 v120, v176, v177
    v_cvt_pk_bf16_f32 v121, v178, v179
    v_cvt_pk_bf16_f32 v122, v180, v181
    v_cvt_pk_bf16_f32 v123, v182, v183
    ds_write_b128 v4, v[120:123] offset:16640
    v_fma_mix_f32 v184, v76, 1.0, v80 op_sel:[0,0,0] op_sel_hi:[1,0,1]
    v_fma_mix_f32 v185, v76, 1.0, v80 op_sel:[1,0,1] op_sel_hi:[1,0,1]
    v_fma_mix_f32 v186, v77, 1.0, v81 op_sel:[0,0,0] op_sel_hi:[1,0,1]
    v_fma_mix_f32 v187, v77, 1.0, v81 op_sel:[1,0,1] op_sel_hi:[1,0,1]
    buffer_load_dwordx4 v[28:31], v3, s[16:19], s53 offen sc0 sc1
    v_fma_mix_f32 v188, v78, 1.0, v82 op_sel:[0,0,0] op_sel_hi:[1,0,1]
    v_fma_mix_f32 v189, v78, 1.0, v82 op_sel:[1,0,1] op_sel_hi:[1,0,1]
    v_fma_mix_f32 v190, v79, 1.0, v83 op_sel:[0,0,0] op_sel_hi:[1,0,1]
    v_fma_mix_f32 v191, v79, 1.0, v83 op_sel:[1,0,1] op_sel_hi:[1,0,1]
    v_cvt_pk_bf16_f32 v124, v184, v185
    v_cvt_pk_bf16_f32 v125, v186, v187
    v_cvt_pk_bf16_f32 v126, v188, v189
    v_cvt_pk_bf16_f32 v127, v190, v191
    ds_write_b128 v4, v[124:127] offset:49920
    v_fma_mix_f32 v176, v80, 1.0, -v76 op_sel:[0,0,0] op_sel_hi:[1,0,1]
    v_fma_mix_f32 v177, v80, 1.0, -v76 op_sel:[1,0,1] op_sel_hi:[1,0,1]
    v_fma_mix_f32 v178, v81, 1.0, -v77 op_sel:[0,0,0] op_sel_hi:[1,0,1]
    v_fma_mix_f32 v179, v81, 1.0, -v77 op_sel:[1,0,1] op_sel_hi:[1,0,1]
    buffer_load_dwordx4 v[32:35], v3, s[16:19], s54 offen sc0 sc1
    v_fma_mix_f32 v180, v82, 1.0, -v78 op_sel:[0,0,0] op_sel_hi:[1,0,1]
    v_fma_mix_f32 v181, v82, 1.0, -v78 op_sel:[1,0,1] op_sel_hi:[1,0,1]
    v_fma_mix_f32 v182, v83, 1.0, -v79 op_sel:[0,0,0] op_sel_hi:[1,0,1]
    v_fma_mix_f32 v183, v83, 1.0, -v79 op_sel:[1,0,1] op_sel_hi:[1,0,1]
    v_cvt_pk_bf16_f32 v128, v176, v177
    v_cvt_pk_bf16_f32 v129, v178, v179
    v_cvt_pk_bf16_f32 v130, v180, v181
    v_cvt_pk_bf16_f32 v131, v182, v183
    ds_write_b128 v5, v[128:131] offset:16640
    v_fma_mix_f32 v184, v76, 1.0, -v84 op_sel:[0,0,0] op_sel_hi:[1,0,1]
    v_fma_mix_f32 v185, v76, 1.0, -v84 op_sel:[1,0,1] op_sel_hi:[1,0,1]
    v_fma_mix_f32 v186, v77, 1.0, -v85 op_sel:[0,0,0] op_sel_hi:[1,0,1]
    v_fma_mix_f32 v187, v77, 1.0, -v85 op_sel:[1,0,1] op_sel_hi:[1,0,1]
    v_fma_mix_f32 v188, v78, 1.0, -v86 op_sel:[0,0,0] op_sel_hi:[1,0,1]
    v_fma_mix_f32 v189, v78, 1.0, -v86 op_sel:[1,0,1] op_sel_hi:[1,0,1]
    v_fma_mix_f32 v190, v79, 1.0, -v87 op_sel:[0,0,0] op_sel_hi:[1,0,1]
    v_fma_mix_f32 v191, v79, 1.0, -v87 op_sel:[1,0,1] op_sel_hi:[1,0,1]
    v_cvt_pk_bf16_f32 v132, v184, v185
    v_cvt_pk_bf16_f32 v133, v186, v187
    v_cvt_pk_bf16_f32 v134, v188, v189
    v_cvt_pk_bf16_f32 v135, v190, v191
    ds_write_b128 v5, v[132:135] offset:49920
    v_fma_mix_f32 v176, v80, 1.0, -v88 op_sel:[0,0,0] op_sel_hi:[1,0,1]
    v_fma_mix_f32 v177, v80, 1.0, -v88 op_sel:[1,0,1] op_sel_hi:[1,0,1]
    v_fma_mix_f32 v178, v81, 1.0, -v89 op_sel:[0,0,0] op_sel_hi:[1,0,1]
    v_fma_mix_f32 v179, v81, 1.0, -v89 op_sel:[1,0,1] op_sel_hi:[1,0,1]
    buffer_load_dwordx4 v[36:39], v3, s[16:19], s55 offen sc0 sc1
    v_fma_mix_f32 v180, v82, 1.0, -v90 op_sel:[0,0,0] op_sel_hi:[1,0,1]
    v_fma_mix_f32 v181, v82, 1.0, -v90 op_sel:[1,0,1] op_sel_hi:[1,0,1]
    v_fma_mix_f32 v182, v83, 1.0, -v91 op_sel:[0,0,0] op_sel_hi:[1,0,1]
    v_fma_mix_f32 v183, v83, 1.0, -v91 op_sel:[1,0,1] op_sel_hi:[1,0,1]
    v_cvt_pk_bf16_f32 v120, v176, v177
    v_cvt_pk_bf16_f32 v121, v178, v179
    v_cvt_pk_bf16_f32 v122, v180, v181
    v_cvt_pk_bf16_f32 v123, v182, v183
    ds_write_b128 v4, v[120:123] offset:20800
    v_fma_mix_f32 v184, v84, 1.0, v88 op_sel:[0,0,0] op_sel_hi:[1,0,1]
    v_fma_mix_f32 v185, v84, 1.0, v88 op_sel:[1,0,1] op_sel_hi:[1,0,1]
    v_fma_mix_f32 v186, v85, 1.0, v89 op_sel:[0,0,0] op_sel_hi:[1,0,1]
    v_fma_mix_f32 v187, v85, 1.0, v89 op_sel:[1,0,1] op_sel_hi:[1,0,1]
    buffer_load_dwordx4 v[40:43], v3, s[16:19], s56 offen sc0 sc1
    v_fma_mix_f32 v188, v86, 1.0, v90 op_sel:[0,0,0] op_sel_hi:[1,0,1]
    v_fma_mix_f32 v189, v86, 1.0, v90 op_sel:[1,0,1] op_sel_hi:[1,0,1]
    v_fma_mix_f32 v190, v87, 1.0, v91 op_sel:[0,0,0] op_sel_hi:[1,0,1]
    v_fma_mix_f32 v191, v87, 1.0, v91 op_sel:[1,0,1] op_sel_hi:[1,0,1]
    v_cvt_pk_bf16_f32 v124, v184, v185
    v_cvt_pk_bf16_f32 v125, v186, v187
    v_cvt_pk_bf16_f32 v126, v188, v189
    v_cvt_pk_bf16_f32 v127, v190, v191
    ds_write_b128 v4, v[124:127] offset:54080
    v_fma_mix_f32 v176, v88, 1.0, -v84 op_sel:[0,0,0] op_sel_hi:[1,0,1]
    v_fma_mix_f32 v177, v88, 1.0, -v84 op_sel:[1,0,1] op_sel_hi:[1,0,1]
    v_fma_mix_f32 v178, v89, 1.0, -v85 op_sel:[0,0,0] op_sel_hi:[1,0,1]
    v_fma_mix_f32 v179, v89, 1.0, -v85 op_sel:[1,0,1] op_sel_hi:[1,0,1]
    buffer_load_dwordx4 v[44:47], v3, s[16:19], s57 offen sc0 sc1
    v_fma_mix_f32 v180, v90, 1.0, -v86 op_sel:[0,0,0] op_sel_hi:[1,0,1]
    v_fma_mix_f32 v181, v90, 1.0, -v86 op_sel:[1,0,1] op_sel_hi:[1,0,1]
    v_fma_mix_f32 v182, v91, 1.0, -v87 op_sel:[0,0,0] op_sel_hi:[1,0,1]
    v_fma_mix_f32 v183, v91, 1.0, -v87 op_sel:[1,0,1] op_sel_hi:[1,0,1]
    v_cvt_pk_bf16_f32 v128, v176, v177
    v_cvt_pk_bf16_f32 v129, v178, v179
    v_cvt_pk_bf16_f32 v130, v180, v181
    v_cvt_pk_bf16_f32 v131, v182, v183
    ds_write_b128 v5, v[128:131] offset:20800
    v_fma_mix_f32 v184, v84, 1.0, -v92 op_sel:[0,0,0] op_sel_hi:[1,0,1]
    v_fma_mix_f32 v185, v84, 1.0, -v92 op_sel:[1,0,1] op_sel_hi:[1,0,1]
    v_fma_mix_f32 v186, v85, 1.0, -v93 op_sel:[0,0,0] op_sel_hi:[1,0,1]
    v_fma_mix_f32 v187, v85, 1.0, -v93 op_sel:[1,0,1] op_sel_hi:[1,0,1]
    v_fma_mix_f32 v188, v86, 1.0, -v94 op_sel:[0,0,0] op_sel_hi:[1,0,1]
    v_fma_mix_f32 v189, v86, 1.0, -v94 op_sel:[1,0,1] op_sel_hi:[1,0,1]
    v_fma_mix_f32 v190, v87, 1.0, -v95 op_sel:[0,0,0] op_sel_hi:[1,0,1]
    v_fma_mix_f32 v191, v87, 1.0, -v95 op_sel:[1,0,1] op_sel_hi:[1,0,1]
    v_cvt_pk_bf16_f32 v132, v184, v185
    v_cvt_pk_bf16_f32 v133, v186, v187
    v_cvt_pk_bf16_f32 v134, v188, v189
    v_cvt_pk_bf16_f32 v135, v190, v191
    ds_write_b128 v5, v[132:135] offset:54080
    v_add_u32 v3, 0x40000, v3
    s_waitcnt lgkmcnt(0)
    s_barrier
    s_waitcnt vmcnt(6)
    v_fma_mix_f32 v176, v96, 1.0, -v104 op_sel:[0,0,0] op_sel_hi:[1,0,1]
    v_fma_mix_f32 v177, v96, 1.0, -v104 op_sel:[1,0,1] op_sel_hi:[1,0,1]
    v_fma_mix_f32 v178, v97, 1.0, -v105 op_sel:[0,0,0] op_sel_hi:[1,0,1]
    v_fma_mix_f32 v179, v97, 1.0, -v105 op_sel:[1,0,1] op_sel_hi:[1,0,1]
    buffer_load_dwordx4 v[48:51], v3, s[16:19], s52 offen sc0 sc1
    v_fma_mix_f32 v180, v98, 1.0, -v106 op_sel:[0,0,0] op_sel_hi:[1,0,1]
    v_fma_mix_f32 v181, v98, 1.0, -v106 op_sel:[1,0,1] op_sel_hi:[1,0,1]
    v_fma_mix_f32 v182, v99, 1.0, -v107 op_sel:[0,0,0] op_sel_hi:[1,0,1]
    v_fma_mix_f32 v183, v99, 1.0, -v107 op_sel:[1,0,1] op_sel_hi:[1,0,1]
    v_cvt_pk_bf16_f32 v120, v176, v177
    v_cvt_pk_bf16_f32 v121, v178, v179
    v_cvt_pk_bf16_f32 v122, v180, v181
    v_cvt_pk_bf16_f32 v123, v182, v183
    ds_write_b128 v4, v[120:123] offset:24960
    v_fma_mix_f32 v184, v100, 1.0, v104 op_sel:[0,0,0] op_sel_hi:[1,0,1]
    v_fma_mix_f32 v185, v100, 1.0, v104 op_sel:[1,0,1] op_sel_hi:[1,0,1]
    v_fma_mix_f32 v186, v101, 1.0, v105 op_sel:[0,0,0] op_sel_hi:[1,0,1]
    v_fma_mix_f32 v187, v101, 1.0, v105 op_sel:[1,0,1] op_sel_hi:[1,0,1]
    buffer_load_dwordx4 v[52:55], v3, s[16:19], s53 offen sc0 sc1
    v_fma_mix_f32 v188, v102, 1.0, v106 op_sel:[0,0,0] op_sel_hi:[1,0,1]
    v_fma_mix_f32 v189, v102, 1.0, v106 op_sel:[1,0,1] op_sel_hi:[1,0,1]
    v_fma_mix_f32 v190, v103, 1.0, v107 op_sel:[0,0,0] op_sel_hi:[1,0,1]
    v_fma_mix_f32 v191, v103, 1.0, v107 op_sel:[1,0,1] op_sel_hi:[1,0,1]
    v_cvt_pk_bf16_f32 v124, v184, v185
    v_cvt_pk_bf16_f32 v125, v186, v187
    v_cvt_pk_bf16_f32 v126, v188, v189
    v_cvt_pk_bf16_f32 v127, v190, v191
    ds_write_b128 v4, v[124:127] offset:58240
    v_fma_mix_f32 v176, v104, 1.0, -v100 op_sel:[0,0,0] op_sel_hi:[1,0,1]
    v_fma_mix_f32 v177, v104, 1.0, -v100 op_sel:[1,0,1] op_sel_hi:[1,0,1]
    v_fma_mix_f32 v178, v105, 1.0, -v101 op_sel:[0,0,0] op_sel_hi:[1,0,1]
    v_fma_mix_f32 v179, v105, 1.0, -v101 op_sel:[1,0,1] op_sel_hi:[1,0,1]
    buffer_load_dwordx4 v[56:59], v3, s[16:19], s54 offen sc0 sc1
    v_fma_mix_f32 v180, v106, 1.0, -v102 op_sel:[0,0,0] op_sel_hi:[1,0,1]
    v_fma_mix_f32 v181, v106, 1.0, -v102 op_sel:[1,0,1] op_sel_hi:[1,0,1]
    v_fma_mix_f32 v182, v107, 1.0, -v103 op_sel:[0,0,0] op_sel_hi:[1,0,1]
    v_fma_mix_f32 v183, v107, 1.0, -v103 op_sel:[1,0,1] op_sel_hi:[1,0,1]
    v_cvt_pk_bf16_f32 v128, v176, v177
    v_cvt_pk_bf16_f32 v129, v178, v179
    v_cvt_pk_bf16_f32 v130, v180, v181
    v_cvt_pk_bf16_f32 v131, v182, v183
    ds_write_b128 v5, v[128:131] offset:24960
    v_fma_mix_f32 v184, v100, 1.0, -v108 op_sel:[0,0,0] op_sel_hi:[1,0,1]
    v_fma_mix_f32 v185, v100, 1.0, -v108 op_sel:[1,0,1] op_sel_hi:[1,0,1]
    v_fma_mix_f32 v186, v101, 1.0, -v109 op_sel:[0,0,0] op_sel_hi:[1,0,1]
    v_fma_mix_f32 v187, v101, 1.0, -v109 op_sel:[1,0,1] op_sel_hi:[1,0,1]
    v_fma_mix_f32 v188, v102, 1.0, -v110 op_sel:[0,0,0] op_sel_hi:[1,0,1]
    v_fma_mix_f32 v189, v102, 1.0, -v110 op_sel:[1,0,1] op_sel_hi:[1,0,1]
    v_fma_mix_f32 v190, v103, 1.0, -v111 op_sel:[0,0,0] op_sel_hi:[1,0,1]
    v_fma_mix_f32 v191, v103, 1.0, -v111 op_sel:[1,0,1] op_sel_hi:[1,0,1]
    v_cvt_pk_bf16_f32 v132, v184, v185
    v_cvt_pk_bf16_f32 v133, v186, v187
    v_cvt_pk_bf16_f32 v134, v188, v189
    v_cvt_pk_bf16_f32 v135, v190, v191
    ds_write_b128 v5, v[132:135] offset:58240
    v_fma_mix_f32 v176, v104, 1.0, -v112 op_sel:[0,0,0] op_sel_hi:[1,0,1]
    v_fma_mix_f32 v177, v104, 1.0, -v112 op_sel:[1,0,1] op_sel_hi:[1,0,1]
    v_fma_mix_f32 v178, v105, 1.0, -v113 op_sel:[0,0,0] op_sel_hi:[1,0,1]
    v_fma_mix_f32 v179, v105, 1.0, -v113 op_sel:[1,0,1] op_sel_hi:[1,0,1]
    buffer_load_dwordx4 v[60:63], v3, s[16:19], s55 offen sc0 sc1
    v_fma_mix_f32 v180, v106, 1.0, -v114 op_sel:[0,0,0] op_sel_hi:[1,0,1]
    v_fma_mix_f32 v181, v106, 1.0, -v114 op_sel:[1,0,1] op_sel_hi:[1,0,1]
    v_fma_mix_f32 v182, v107, 1.0, -v115 op_sel:[0,0,0] op_sel_hi:[1,0,1]
    v_fma_mix_f32 v183, v107, 1.0, -v115 op_sel:[1,0,1] op_sel_hi:[1,0,1]
    v_cvt_pk_bf16_f32 v120, v176, v177
    v_cvt_pk_bf16_f32 v121, v178, v179
    v_cvt_pk_bf16_f32 v122, v180, v181
    v_cvt_pk_bf16_f32 v123, v182, v183
    ds_write_b128 v4, v[120:123] offset:29120
    v_fma_mix_f32 v184, v108, 1.0, v112 op_sel:[0,0,0] op_sel_hi:[1,0,1]
    v_fma_mix_f32 v185, v108, 1.0, v112 op_sel:[1,0,1] op_sel_hi:[1,0,1]
    v_fma_mix_f32 v186, v109, 1.0, v113 op_sel:[0,0,0] op_sel_hi:[1,0,1]
    v_fma_mix_f32 v187, v109, 1.0, v113 op_sel:[1,0,1] op_sel_hi:[1,0,1]
    buffer_load_dwordx4 v[64:67], v3, s[16:19], s56 offen sc0 sc1
    v_fma_mix_f32 v188, v110, 1.0, v114 op_sel:[0,0,0] op_sel_hi:[1,0,1]
    v_fma_mix_f32 v189, v110, 1.0, v114 op_sel:[1,0,1] op_sel_hi:[1,0,1]
    v_fma_mix_f32 v190, v111, 1.0, v115 op_sel:[0,0,0] op_sel_hi:[1,0,1]
    v_fma_mix_f32 v191, v111, 1.0, v115 op_sel:[1,0,1] op_sel_hi:[1,0,1]
    v_cvt_pk_bf16_f32 v124, v184, v185
    v_cvt_pk_bf16_f32 v125, v186, v187
    v_cvt_pk_bf16_f32 v126, v188, v189
    v_cvt_pk_bf16_f32 v127, v190, v191
    ds_write_b128 v4, v[124:127] offset:62400
    v_fma_mix_f32 v176, v112, 1.0, -v108 op_sel:[0,0,0] op_sel_hi:[1,0,1]
    v_fma_mix_f32 v177, v112, 1.0, -v108 op_sel:[1,0,1] op_sel_hi:[1,0,1]
    v_fma_mix_f32 v178, v113, 1.0, -v109 op_sel:[0,0,0] op_sel_hi:[1,0,1]
    v_fma_mix_f32 v179, v113, 1.0, -v109 op_sel:[1,0,1] op_sel_hi:[1,0,1]
    buffer_load_dwordx4 v[68:71], v3, s[16:19], s57 offen sc0 sc1
    v_fma_mix_f32 v180, v114, 1.0, -v110 op_sel:[0,0,0] op_sel_hi:[1,0,1]
    v_fma_mix_f32 v181, v114, 1.0, -v110 op_sel:[1,0,1] op_sel_hi:[1,0,1]
    v_fma_mix_f32 v182, v115, 1.0, -v111 op_sel:[0,0,0] op_sel_hi:[1,0,1]
    v_fma_mix_f32 v183, v115, 1.0, -v111 op_sel:[1,0,1] op_sel_hi:[1,0,1]
    v_cvt_pk_bf16_f32 v128, v176, v177
    v_cvt_pk_bf16_f32 v129, v178, v179
    v_cvt_pk_bf16_f32 v130, v180, v181
    v_cvt_pk_bf16_f32 v131, v182, v183
    ds_write_b128 v5, v[128:131] offset:29120
    v_fma_mix_f32 v184, v108, 1.0, -v116 op_sel:[0,0,0] op_sel_hi:[1,0,1]
    v_fma_mix_f32 v185, v108, 1.0, -v116 op_sel:[1,0,1] op_sel_hi:[1,0,1]
    v_fma_mix_f32 v186, v109, 1.0, -v117 op_sel:[0,0,0] op_sel_hi:[1,0,1]
    v_fma_mix_f32 v187, v109, 1.0, -v117 op_sel:[1,0,1] op_sel_hi:[1,0,1]
    v_fma_mix_f32 v188, v110, 1.0, -v118 op_sel:[0,0,0] op_sel_hi:[1,0,1]
    v_fma_mix_f32 v189, v110, 1.0, -v118 op_sel:[1,0,1] op_sel_hi:[1,0,1]
    v_fma_mix_f32 v190, v111, 1.0, -v119 op_sel:[0,0,0] op_sel_hi:[1,0,1]
    v_fma_mix_f32 v191, v111, 1.0, -v119 op_sel:[1,0,1] op_sel_hi:[1,0,1]
    v_cvt_pk_bf16_f32 v132, v184, v185
    v_cvt_pk_bf16_f32 v133, v186, v187
    v_cvt_pk_bf16_f32 v134, v188, v189
    v_cvt_pk_bf16_f32 v135, v190, v191
    ds_write_b128 v5, v[132:135] offset:62400
    v_add_u32 v3, 0x40000, v3
    s_waitcnt lgkmcnt(0)
    s_barrier
    s_add_u32 s58, s58, 1
    s_cmp_lt_u32 s58, 4
    s_cbranch_scc1 L_ploop
    s_waitcnt vmcnt(0)
    s_cmp_eq_u32 s89, 0
    s_cbranch_scc1 L_pph0
    s_lshl_b32 s3, s43, 12
    s_add_u32 s3, s3, 117312
    v_add_u32 v10, s3, v6
    ds_write_b128 v10, v[224:227] offset:0
    ds_write_b128 v10, v[228:231] offset:1024
    ds_write_b128 v10, v[232:235] offset:2048
    ds_write_b128 v10, v[236:239] offset:3072
    s_waitcnt lgkmcnt(0)
    s_branch L_pextra_done
L_pph0:
    s_cmp_eq_u32 s43, 4
    s_cbranch_scc1 L_pemb
    s_mov_b32 s39, s60
    s_add_u32 s12, s86, 0x1800000
    s_addc_u32 s13, s87, 0
    s_mov_b32 s14, 0x600000
    s_mov_b32 s15, 0x20000
    buffer_store_dwordx4 v[160:163], v6, s[12:15], s39 offen sc0 sc1
    s_add_u32 s39, s39, 196608
    buffer_store_dwordx4 v[164:167], v6, s[12:15], s39 offen sc0 sc1
    s_add_u32 s39, s39, 196608
    buffer_store_dwordx4 v[168:171], v6, s[12:15], s39 offen sc0 sc1
    s_add_u32 s39, s39, 196608
    buffer_store_dwordx4 v[172:175], v6, s[12:15], s39 offen sc0 sc1
    s_add_u32 s39, s39, 196608
    s_nop 1
    s_mov_b32 s39, s61
    s_add_u32 s12, s86, 0x1800000
    s_addc_u32 s13, s87, 0
    s_mov_b32 s14, 0x600000
    s_mov_b32 s15, 0x20000
    buffer_store_dwordx4 v[142:145], v6, s[12:15], s39 offen sc0 sc1
    s_add_u32 s39, s39, 196608
    buffer_store_dwordx4 v[146:149], v6, s[12:15], s39 offen sc0 sc1
    s_add_u32 s39, s39, 196608
    buffer_store_dwordx4 v[150:153], v6, s[12:15], s39 offen sc0 sc1
    s_add_u32 s39, s39, 196608
    buffer_store_dwordx4 v[154:157], v6, s[12:15], s39 offen sc0 sc1
    s_add_u32 s39, s39, 196608
    s_nop 1
    s_branch L_pextra_done
L_pemb:
    s_add_u32 s12, s86, 0x2040000
    s_addc_u32 s13, s87, 0
    s_mov_b32 s14, 0x10000
    s_mov_b32 s15, 0x20000
    s_lshl_b32 s3, s41, 11
    s_lshl_b32 s4, s40, 8
    s_add_u32 s3, s3, s4
    v_lshlrev_b32 v10, 2, v2
    buffer_load_dword v24, v10, s[12:15], s3 offen sc0 sc1
    s_add_u32 s3, s3, 4096
    buffer_load_dword v25, v10, s[12:15], s3 offen sc0 sc1
    s_add_u32 s3, s3, 4096
    buffer_load_dword v26, v10, s[12:15], s3 offen sc0 sc1
    s_add_u32 s3, s3, 4096
    buffer_load_dword v27, v10, s[12:15], s3 offen sc0 sc1
    s_add_u32 s3, s3, 4096
    buffer_load_dword v28, v10, s[12:15], s3 offen sc0 sc1
    s_add_u32 s3, s3, 4096
    buffer_load_dword v29, v10, s[12:15], s3 offen sc0 sc1
    s_add_u32 s3, s3, 4096
    buffer_load_dword v30, v10, s[12:15], s3 offen sc0 sc1
    s_add_u32 s3, s3, 4096
    buffer_load_dword v31, v10, s[12:15], s3 offen sc0 sc1
    s_add_u32 s3, s3, 4096
    buffer_load_dword v32, v10, s[12:15], s3 offen sc0 sc1
    s_add_u32 s3, s3, 4096
    buffer_load_dword v33, v10, s[12:15], s3 offen sc0 sc1
    s_add_u32 s3, s3, 4096
    buffer_load_dword v34, v10, s[12:15], s3 offen sc0 sc1
    s_add_u32 s3, s3, 4096
    buffer_load_dword v35, v10, s[12:15], s3 offen sc0 sc1
    s_add_u32 s3, s3, 4096
    buffer_load_dword v36, v10, s[12:15], s3 offen sc0 sc1
    s_add_u32 s3, s3, 4096
    buffer_load_dword v37, v10, s[12:15], s3 offen sc0 sc1
    s_add_u32 s3, s3, 4096
    buffer_load_dword v38, v10, s[12:15], s3 offen sc0 sc1
    s_add_u32 s3, s3, 4096
    buffer_load_dword v39, v10, s[12:15], s3 offen sc0 sc1
    s_waitcnt vmcnt(0)
    v_add_f32 v24, v24, v32
    v_add_f32 v25, v25, v33
    v_add_f32 v26, v26, v34
    v_add_f32 v27, v27, v35
    v_add_f32 v28, v28, v36
    v_add_f32 v29, v29, v37
    v_add_f32 v30, v30, v38
    v_add_f32 v31, v31, v39
    v_add_f32 v24, v24, v28
    v_add_f32 v25, v25, v29
    v_add_f32 v26, v26, v30
    v_add_f32 v27, v27, v31
    v_add_f32 v24, v24, v26
    v_add_f32 v25, v25, v27
    v_add_f32 v24, v24, v25
    v_add_u32 v10, 133440, v10
    ds_write_b32 v10, v24
    s_waitcnt lgkmcnt(0)
L_pextra_done:
    s_cmp_lg_u32 s89, 0
    s_cbranch_scc1 L_el_15
    s_mov_b32 s24, s76
    s_mov_b32 s25, s77
    s_mov_b32 s26, 0x400
    s_mov_b32 s27, 0x20000
    s_mov_b32 s28, s78
    s_mov_b32 s29, s79
    s_mov_b32 s30, 0x400
    s_mov_b32 s31, 0x20000
    s_and_b32 s4, s43, 1
    s_lshl_b32 s4, s4, 6
    s_lshl_b32 s3, s40, 7
    s_add_u32 s3, s3, s4
    v_lshlrev_b32 v13, 4, v9
    buffer_load_dwordx4 v[104:107], v13, s[24:27], s3 offen
    buffer_load_dwordx4 v[108:111], v13, s[28:31], s3 offen
    s_branch L_eld_16
L_el_15:
    s_lshl_b32 s3, s41, 22
    s_lshl_b32 s4, s40, 19
    s_add_u32 s3, s3, s4
    s_lshr_b32 s4, s43, 2
    s_lshl_b32 s4, s4, 18
    s_add_u32 s3, s3, s4
    s_bfe_u32 s4, s43, 0x10001
    s_lshl_b32 s4, s4, 15
    s_add_u32 s3, s3, s4
    s_lshl_b32 s4, s42, 9
    s_add_u32 s3, s3, s4
    s_and_b32 s4, s43, 1
    s_lshl_b32 s4, s4, 8
    s_add_u32 s60, s3, s4
    s_add_u32 s61, s60, 8192
    s_add_u32 s62, s60, 16384
    s_add_u32 s63, s60, 24576
    v_lshlrev_b32 v13, 16, v9
    v_lshl_add_u32 v13, v8, 3, v13
L_eld_16:
L_epi:
    s_barrier
    s_cmp_lg_u32 s89, 0
    s_cbranch_scc1 L_epi2
    s_and_b32 s59, s43, 1
    s_lshr_b32 s3, s43, 1
    s_lshl_b32 s4, s59, 4
    s_lshl_b32 s3, s3, 1
    s_add_u32 s4, s4, s3
    s_mul_i32 s4, s4, 1040
    v_add_u32 v10, s4, v6
    v_add_u32 v11, 66560, v10
    v_mov_b32 v12, 0
    ds_read_b32 v16, v12
    ds_read_b32 v17, v12 offset:33280
    v_mov_b32 v12, 66560
    ds_read_b32 v18, v12
    s_lshl_b32 s3, s59, 7
    s_add_u32 s3, s3, 133440
    v_lshl_add_u32 v12, v9, 5, s3
    ds_read_b128 v[48:51], v12
    ds_read_b128 v[52:55], v12 offset:16
    ds_read_b128 v[112:115], v10 offset:0
    ds_read_b128 v[116:119], v10 offset:8320
    ds_read_b128 v[120:123], v10 offset:33280
    ds_read_b128 v[124:127], v10 offset:41600
    ds_read_b128 v[128:131], v11 offset:0
    ds_read_b128 v[132:135], v11 offset:8320
    ds_read_b128 v[136:139], v11 offset:33280
    ds_read_b128 v[140:143], v11 offset:41600
    ds_read_b128 v[144:147], v10 offset:1040
    ds_read_b128 v[148:151], v10 offset:9360
    ds_read_b128 v[152:155], v10 offset:34320
    ds_read_b128 v[156:159], v10 offset:42640
    ds_read_b128 v[160:163], v11 offset:1040
    ds_read_b128 v[164:167], v11 offset:9360
    ds_read_b128 v[168:171], v11 offset:34320
    ds_read_b128 v[172:175], v11 offset:42640
    s_waitcnt lgkmcnt(8)
    v_add_f32 v17, v17, v18
    v_fma_f32 v20, v17, 0.5, v16
    v_mul_f32 v20, s90, v20
    v_pk_add_f32 v[48:49], v[48:49], v[20:21] op_sel_hi:[1,0] neg_lo:[0,1] neg_hi:[0,1]
    v_pk_add_f32 v[50:51], v[50:51], v[20:21] op_sel_hi:[1,0] neg_lo:[0,1] neg_hi:[0,1]
    v_pk_add_f32 v[52:53], v[52:53], v[20:21] op_sel_hi:[1,0] neg_lo:[0,1] neg_hi:[0,1]
    v_pk_add_f32 v[54:55], v[54:55], v[20:21] op_sel_hi:[1,0] neg_lo:[0,1] neg_hi:[0,1]
    v_pk_add_f32 v[176:177], v[120:121], v[128:129]
    v_pk_add_f32 v[184:185], v[120:121], v[128:129] neg_lo:[0,1] neg_hi:[0,1]
    v_pk_fma_f32 v[112:113], v[112:113], s[90:91], v[48:49] op_sel_hi:[1,0,1]
    v_pk_fma_f32 v[136:137], v[136:137], s[90:91], v[48:49] op_sel_hi:[1,0,1] neg_lo:[1,0,0] neg_hi:[1,0,0]
    v_pk_fma_f32 v[176:177], v[176:177], s[90:91], v[112:113] op_sel:[0,1,0]
    v_pk_fma_f32 v[184:185], v[184:185], s[90:91], v[136:137] op_sel:[0,1,0]
    v_pk_add_f32 v[178:179], v[122:123], v[130:131]
    v_pk_add_f32 v[186:187], v[122:123], v[130:131] neg_lo:[0,1] neg_hi:[0,1]
    v_pk_fma_f32 v[114:115], v[114:115], s[90:91], v[50:51] op_sel_hi:[1,0,1]
    v_pk_fma_f32 v[138:139], v[138:139], s[90:91], v[50:51] op_sel_hi:[1,0,1] neg_lo:[1,0,0] neg_hi:[1,0,0]
    v_pk_fma_f32 v[178:179], v[178:179], s[90:91], v[114:115] op_sel:[0,1,0]
    v_pk_fma_f32 v[186:187], v[186:187], s[90:91], v[138:139] op_sel:[0,1,0]
    v_pk_add_f32 v[180:181], v[124:125], v[132:133]
    v_pk_add_f32 v[188:189], v[124:125], v[132:133] neg_lo:[0,1] neg_hi:[0,1]
    v_pk_fma_f32 v[116:117], v[116:117], s[90:91], v[52:53] op_sel_hi:[1,0,1]
    v_pk_fma_f32 v[140:141], v[140:141], s[90:91], v[52:53] op_sel_hi:[1,0,1] neg_lo:[1,0,0] neg_hi:[1,0,0]
    v_pk_fma_f32 v[180:181], v[180:181], s[90:91], v[116:117] op_sel:[0,1,0]
    v_pk_fma_f32 v[188:189], v[188:189], s[90:91], v[140:141] op_sel:[0,1,0]
    v_pk_add_f32 v[182:183], v[126:127], v[134:135]
    v_pk_add_f32 v[190:191], v[126:127], v[134:135] neg_lo:[0,1] neg_hi:[0,1]
    v_pk_fma_f32 v[118:119], v[118:119], s[90:91], v[54:55] op_sel_hi:[1,0,1]
    v_pk_fma_f32 v[142:143], v[142:143], s[90:91], v[54:55] op_sel_hi:[1,0,1] neg_lo:[1,0,0] neg_hi:[1,0,0]
    v_pk_fma_f32 v[182:183], v[182:183], s[90:91], v[118:119] op_sel:[0,1,0]
    v_pk_fma_f32 v[190:191], v[190:191], s[90:91], v[142:143] op_sel:[0,1,0]
    s_waitcnt lgkmcnt(0)
    v_pk_add_f32 v[192:193], v[152:153], v[160:161]
    v_pk_add_f32 v[200:201], v[152:153], v[160:161] neg_lo:[0,1] neg_hi:[0,1]
    v_pk_fma_f32 v[144:145], v[144:145], s[90:91], v[48:49] op_sel_hi:[1,0,1]
    v_pk_fma_f32 v[168:169], v[168:169], s[90:91], v[48:49] op_sel_hi:[1,0,1] neg_lo:[1,0,0] neg_hi:[1,0,0]
    v_pk_fma_f32 v[192:193], v[192:193], s[90:91], v[144:145] op_sel:[0,1,0]
    v_pk_fma_f32 v[200:201], v[200:201], s[90:91], v[168:169] op_sel:[0,1,0]
    v_pk_add_f32 v[194:195], v[154:155], v[162:163]
    v_pk_add_f32 v[202:203], v[154:155], v[162:163] neg_lo:[0,1] neg_hi:[0,1]
    v_pk_fma_f32 v[146:147], v[146:147], s[90:91], v[50:51] op_sel_hi:[1,0,1]
    v_pk_fma_f32 v[170:171], v[170:171], s[90:91], v[50:51] op_sel_hi:[1,0,1] neg_lo:[1,0,0] neg_hi:[1,0,0]
    v_pk_fma_f32 v[194:195], v[194:195], s[90:91], v[146:147] op_sel:[0,1,0]
    v_pk_fma_f32 v[202:203], v[202:203], s[90:91], v[170:171] op_sel:[0,1,0]
    v_pk_add_f32 v[196:197], v[156:157], v[164:165]
    v_pk_add_f32 v[204:205], v[156:157], v[164:165] neg_lo:[0,1] neg_hi:[0,1]
    v_pk_fma_f32 v[148:149], v[148:149], s[90:91], v[52:53] op_sel_hi:[1,0,1]
    v_pk_fma_f32 v[172:173], v[172:173], s[90:91], v[52:53] op_sel_hi:[1,0,1] neg_lo:[1,0,0] neg_hi:[1,0,0]
    v_pk_fma_f32 v[196:197], v[196:197], s[90:91], v[148:149] op_sel:[0,1,0]
    v_pk_fma_f32 v[204:205], v[204:205], s[90:91], v[172:173] op_sel:[0,1,0]
    v_pk_add_f32 v[198:199], v[158:159], v[166:167]
    v_pk_add_f32 v[206:207], v[158:159], v[166:167] neg_lo:[0,1] neg_hi:[0,1]
    v_pk_fma_f32 v[150:151], v[150:151], s[90:91], v[54:55] op_sel_hi:[1,0,1]
    v_pk_fma_f32 v[174:175], v[174:175], s[90:91], v[54:55] op_sel_hi:[1,0,1] neg_lo:[1,0,0] neg_hi:[1,0,0]
    v_pk_fma_f32 v[198:199], v[198:199], s[90:91], v[150:151] op_sel:[0,1,0]
    v_pk_fma_f32 v[206:207], v[206:207], s[90:91], v[174:175] op_sel:[0,1,0]
    v_pk_add_f32 v[24:25], v[176:177], v[180:181]
    v_pk_mul_f32 v[26:27], v[176:177], v[176:177]
    v_pk_add_f32 v[28:29], v[178:179], v[182:183]
    v_pk_mul_f32 v[30:31], v[178:179], v[178:179]
    v_pk_fma_f32 v[26:27], v[180:181], v[180:181], v[26:27]
    v_pk_fma_f32 v[30:31], v[182:183], v[182:183], v[30:31]
    v_pk_add_f32 v[24:25], v[24:25], v[184:185]
    v_pk_fma_f32 v[26:27], v[184:185], v[184:185], v[26:27]
    v_pk_add_f32 v[28:29], v[28:29], v[186:187]
    v_pk_fma_f32 v[30:31], v[186:187], v[186:187], v[30:31]
    v_pk_add_f32 v[24:25], v[24:25], v[188:189]
    v_pk_fma_f32 v[26:27], v[188:189], v[188:189], v[26:27]
    v_pk_add_f32 v[28:29], v[28:29], v[190:191]
    v_pk_fma_f32 v[30:31], v[190:191], v[190:191], v[30:31]
    v_pk_add_f32 v[24:25], v[24:25], v[192:193]
    v_pk_fma_f32 v[26:27], v[192:193], v[192:193], v[26:27]
    v_pk_add_f32 v[28:29], v[28:29], v[194:195]
    v_pk_fma_f32 v[30:31], v[194:195], v[194:195], v[30:31]
    v_pk_add_f32 v[24:25], v[24:25], v[196:197]
    v_pk_fma_f32 v[26:27], v[196:197], v[196:197], v[26:27]
    v_pk_add_f32 v[28:29], v[28:29], v[198:199]
    v_pk_fma_f32 v[30:31], v[198:199], v[198:199], v[30:31]
    v_pk_add_f32 v[24:25], v[24:25], v[200:201]
    v_pk_fma_f32 v[26:27], v[200:201], v[200:201], v[26:27]
    v_pk_add_f32 v[28:29], v[28:29], v[202:203]
    v_pk_fma_f32 v[30:31], v[202:203], v[202:203], v[30:31]
    v_pk_add_f32 v[24:25], v[24:25], v[204:205]
    v_pk_fma_f32 v[26:27], v[204:205], v[204:205], v[26:27]
    v_pk_add_f32 v[28:29], v[28:29], v[206:207]
    v_pk_fma_f32 v[30:31], v[206:207], v[206:207], v[30:31]
    v_pk_add_f32 v[24:25], v[24:25], v[28:29]
    v_pk_add_f32 v[26:27], v[26:27], v[30:31]
    v_add_f32 v24, v24, v25
    v_add_f32 v25, v26, v27
    s_nop 1
    v_add_f32_dpp v24, v24, v24 quad_perm:[1,0,3,2] row_mask:0xf bank_mask:0xf
    v_add_f32_dpp v25, v25, v25 quad_perm:[1,0,3,2] row_mask:0xf bank_mask:0xf
    s_nop 0
    v_add_f32_dpp v24, v24, v24 quad_perm:[2,3,0,1] row_mask:0xf bank_mask:0xf
    v_add_f32_dpp v25, v25, v25 quad_perm:[2,3,0,1] row_mask:0xf bank_mask:0xf
    s_nop 0
    v_add_f32_dpp v24, v24, v24 row_half_mirror row_mask:0xf bank_mask:0xf
    v_add_f32_dpp v25, v25, v25 row_half_mirror row_mask:0xf bank_mask:0xf
    s_nop 0
    v_add_f32_dpp v24, v24, v24 row_mirror row_mask:0xf bank_mask:0xf
    v_add_f32_dpp v25, v25, v25 row_mirror row_mask:0xf bank_mask:0xf
    s_nop 0
    s_lshl_b32 s3, s43, 5
    s_add_u32 s3, s3, 133120
    v_lshl_add_u32 v12, v9, 3, s3
    ds_write_b64 v12, v[24:25]
    s_waitcnt lgkmcnt(0)
    s_waitcnt vmcnt(0)
    s_barrier
    s_cmp_lg_u32 s43, 0
    s_cbranch_scc1 L_edone
L_e0:
    s_lshl_b32 s51, s41, 2
    s_lshr_b32 s3, s40, 1
    s_add_u32 s51, s51, s3
    s_lshl_b32 s51, s51, 12
    s_add_u32 s51, s51, 65536
    s_and_b32 s50, s40, 1
    s_lshl_b32 s50, s50, 4
    s_add_u32 s50, s50, s42
    s_lshl_b32 s50, s50, 7
    s_add_u32 s50, s50, s51
    v_lshlrev_b32 v12, 4, v8
    v_add_u32 v12, 133120, v12
    ds_read_b128 v[24:27], v12
    v_and_b32 v13, 31, v2
    v_lshlrev_b32 v13, 7, v13
    s_xor_b32 s7, s51, 0x4000
    s_sub_u32 s7, s7, s51
    v_lshrrev_b32 v14, 5, v2
    v_mul_lo_u32 v14, v14, s7
    v_add_u32 v13, v13, v14
    v_add_u32 v13, s51, v13
    v_mov_b32 v29, s88
    v_mov_b32 v31, s88
    v_mov_b32 v14, 0
    s_waitcnt lgkmcnt(0)
    v_add_f32 v24, v24, v26
    v_add_f32 v25, v25, v27
    s_nop 1
    v_add_f32_dpp v24, v24, v24 quad_perm:[1,0,3,2] row_mask:0xf bank_mask:0xf
    v_add_f32_dpp v25, v25, v25 quad_perm:[1,0,3,2] row_mask:0xf bank_mask:0xf
    s_nop 0
    v_add_f32_dpp v24, v24, v24 quad_perm:[2,3,0,1] row_mask:0xf bank_mask:0xf
    v_add_f32_dpp v25, v25, v25 quad_perm:[2,3,0,1] row_mask:0xf bank_mask:0xf
    s_nop 0
    v_add_f32_dpp v24, v24, v24 row_half_mirror row_mask:0xf bank_mask:0xf
    v_add_f32_dpp v25, v25, v25 row_half_mirror row_mask:0xf bank_mask:0xf
    s_nop 0
    v_add_f32_dpp v24, v24, v24 row_mirror row_mask:0xf bank_mask:0xf
    v_add_f32_dpp v25, v25, v25 row_mirror row_mask:0xf bank_mask:0xf
    s_nop 0
    v_mul_f32 v26, 0x38800000, v24
    v_add_f32 v28, v20, v26
    v_fma_f32 v30, -v24, v26, v25
    v_max_f32 v30, 0, v30
    s_mov_b64 exec, 1
    buffer_store_dwordx4 v[28:31], v14, s[20:23], s50 offen sc0 sc1
    s_mov_b64 exec, -1
    s_sleep 8
    s_mov_b32 s5, 0
L_poll_17:
    buffer_load_dwordx4 v[32:35], v13, s[20:23], 0 offen sc0 sc1
    s_waitcnt vmcnt(0)
    v_cmp_ne_u32 vcc, s88, v33
    v_cmp_ne_u32 s[6:7], s88, v35
    s_or_b64 vcc, vcc, s[6:7]
    s_cbranch_scc0 L_polld_18
    s_add_u32 s5, s5, 1
    s_cmp_lt_u32 s5, 0x80000
    s_cbranch_scc0 L_polld_18
    s_sleep 1
    s_branch L_poll_17
L_polld_18:
    v_readfirstlane_b32 s6, v32
    s_nop 1
    v_subrev_f32 v36, s6, v32
    v_mul_f32 v37, v36, v36
    s_nop 1
    v_add_f32_dpp v36, v36, v36 quad_perm:[1,0,3,2] row_mask:0xf bank_mask:0xf
    v_add_f32_dpp v37, v37, v37 quad_perm:[1,0,3,2] row_mask:0xf bank_mask:0xf
    v_add_f32_dpp v34, v34, v34 quad_perm:[1,0,3,2] row_mask:0xf bank_mask:0xf
    v_add_f32_dpp v36, v36, v36 quad_perm:[2,3,0,1] row_mask:0xf bank_mask:0xf
    v_add_f32_dpp v37, v37, v37 quad_perm:[2,3,0,1] row_mask:0xf bank_mask:0xf
    v_add_f32_dpp v34, v34, v34 quad_perm:[2,3,0,1] row_mask:0xf bank_mask:0xf
    v_add_f32_dpp v36, v36, v36 row_half_mirror row_mask:0xf bank_mask:0xf
    v_add_f32_dpp v37, v37, v37 row_half_mirror row_mask:0xf bank_mask:0xf
    v_add_f32_dpp v34, v34, v34 row_half_mirror row_mask:0xf bank_mask:0xf
    v_add_f32_dpp v36, v36, v36 row_mirror row_mask:0xf bank_mask:0xf
    v_add_f32_dpp v37, v37, v37 row_mirror row_mask:0xf bank_mask:0xf
    v_add_f32_dpp v34, v34, v34 row_mirror row_mask:0xf bank_mask:0xf
    v_add_f32_dpp v36, v36, v36 row_bcast:15 row_mask:0xa bank_mask:0xf
    v_add_f32_dpp v37, v37, v37 row_bcast:15 row_mask:0xa bank_mask:0xf
    v_add_f32_dpp v34, v34, v34 row_bcast:15 row_mask:0xa bank_mask:0xf
    v_mul_f32 v41, 0x3d000000, v36
    v_fma_f32 v42, -v36, v41, v37
    v_max_f32 v42, 0, v42
    v_fmac_f32 v34, 0x46800000, v42
    v_mov_b32 v43, 0x3727c5ac
    v_fmac_f32 v43, 0x36000000, v34
    v_add_f32 v42, s6, v41
    v_rsq_f32 v43, v43
    v_mov_b32 v12, 133376
    s_mov_b32 exec_lo, 0x80000000
    s_mov_b32 exec_hi, 0
    ds_write_b64 v12, v[42:43]
    s_mov_b64 exec, -1
    s_waitcnt lgkmcnt(0)
L_edone:
    s_add_u32 s8, s86, 0x800000
    s_addc_u32 s9, s87, 0
    s_mov_b32 s10, 0x800000
    s_mov_b32 s11, 0x20000
    s_lshl_b32 s56, s41, 4
    s_lshl_b32 s57, s40, 1
    s_add_u32 s56, s56, s57
    s_add_u32 s56, s56, s59
    s_lshl_b32 s56, s56, 18
    s_lshl_b32 s57, s42, 14
    s_add_u32 s56, s56, s57
    s_lshr_b32 s57, s43, 2
    s_lshl_b32 s57, s57, 13
    s_add_u32 s56, s56, s57
    s_bfe_u32 s57, s43, 0x10001
    s_lshl_b32 s57, s57, 11
    s_add_u32 s56, s56, s57
    s_add_u32 s57, s56, 4096
    v_bfe_u32 v11, v8, 2, 1
    v_lshlrev_b32 v11, 1, v11
    v_xor_b32 v11, v11, v9
    v_lshlrev_b32 v11, 4, v11
    v_lshl_add_u32 v11, v8, 6, v11
    v_lshrrev_b32 v12, 3, v2
    v_min_u32 v12, 2, v12
    v_add_u32 v12, s42, v12
    v_max_u32 v12, 1, v12
    v_min_u32 v12, 16, v12
    s_lshl_b32 s3, s41, 4
    s_sub_u32 s3, s3, 1
    v_add_u32 v12, s3, v12
    v_and_b32 v13, 7, v2
    v_lshl_add_u32 v12, v12, 3, v13
    s_lshl_b32 s50, s44, 3
    s_add_u32 s50, s50, s40
    v_lshlrev_b32 v12, 7, v12
    v_add_u32 v23, 98304, v12
    s_lshl_b32 s50, s50, 7
    s_add_u32 s50, s50, 98304
    v_mov_b32 v12, 133376
    s_barrier
    ds_read_b64 v[16:17], v12
    s_mov_b32 s90, s92
    s_mov_b32 s89, 1
    v_lshlrev_b32 v24, 16, v104
    v_and_b32 v25, 0xffff0000, v104
    v_lshlrev_b32 v32, 16, v108
    v_and_b32 v33, 0xffff0000, v108
    v_lshlrev_b32 v26, 16, v105
    v_and_b32 v27, 0xffff0000, v105
    v_lshlrev_b32 v34, 16, v109
    v_and_b32 v35, 0xffff0000, v109
    v_lshlrev_b32 v28, 16, v106
    v_and_b32 v29, 0xffff0000, v106
    v_lshlrev_b32 v36, 16, v110
    v_and_b32 v37, 0xffff0000, v110
    v_lshlrev_b32 v30, 16, v107
    v_and_b32 v31, 0xffff0000, v107
    v_lshlrev_b32 v38, 16, v111
    v_and_b32 v39, 0xffff0000, v111
    s_waitcnt lgkmcnt(0)
    v_sub_f32 v16, v16, v20
    v_pk_mul_f32 v[24:25], v[24:25], v[16:17] op_sel:[0,1]
    v_pk_mul_f32 v[26:27], v[26:27], v[16:17] op_sel:[0,1]
    v_pk_mul_f32 v[28:29], v[28:29], v[16:17] op_sel:[0,1]
    v_pk_mul_f32 v[30:31], v[30:31], v[16:17] op_sel:[0,1]
    v_pk_fma_f32 v[32:33], v[24:25], v[16:17], v[32:33] op_sel_hi:[1,0,1] neg_lo:[1,0,0] neg_hi:[1,0,0]
    v_pk_fma_f32 v[34:35], v[26:27], v[16:17], v[34:35] op_sel_hi:[1,0,1] neg_lo:[1,0,0] neg_hi:[1,0,0]
    v_pk_fma_f32 v[36:37], v[28:29], v[16:17], v[36:37] op_sel_hi:[1,0,1] neg_lo:[1,0,0] neg_hi:[1,0,0]
    v_pk_fma_f32 v[38:39], v[30:31], v[16:17], v[38:39] op_sel_hi:[1,0,1] neg_lo:[1,0,0] neg_hi:[1,0,0]
    v_pk_fma_f32 v[176:177], v[176:177], v[24:25], v[32:33]
    v_pk_fma_f32 v[178:179], v[178:179], v[26:27], v[34:35]
    v_pk_fma_f32 v[180:181], v[180:181], v[28:29], v[36:37]
    v_pk_fma_f32 v[182:183], v[182:183], v[30:31], v[38:39]
    v_pk_fma_f32 v[184:185], v[184:185], v[24:25], v[32:33]
    v_pk_fma_f32 v[186:187], v[186:187], v[26:27], v[34:35]
    v_pk_fma_f32 v[188:189], v[188:189], v[28:29], v[36:37]
    v_pk_fma_f32 v[190:191], v[190:191], v[30:31], v[38:39]
    v_pk_mul_f32 v[40:41], v[176:177], s[92:93] op_sel:[0,1]
    v_pk_mul_f32 v[42:43], v[178:179], s[92:93] op_sel:[0,1]
    v_pk_mul_f32 v[44:45], v[180:181], s[92:93] op_sel:[0,1]
    v_pk_mul_f32 v[46:47], v[182:183], s[92:93] op_sel:[0,1]
    v_pk_mul_f32 v[48:49], v[184:185], s[92:93] op_sel:[0,1]
    v_pk_mul_f32 v[50:51], v[186:187], s[92:93] op_sel:[0,1]
    v_pk_mul_f32 v[52:53], v[188:189], s[92:93] op_sel:[0,1]
    v_pk_mul_f32 v[54:55], v[190:191], s[92:93] op_sel:[0,1]
    v_exp_f32 v40, v40
    v_exp_f32 v41, v41
    v_exp_f32 v42, v42
    v_exp_f32 v43, v43
    v_exp_f32 v44, v44
    v_exp_f32 v45, v45
    v_exp_f32 v46, v46
    v_exp_f32 v47, v47
    v_exp_f32 v48, v48
    v_exp_f32 v49, v49
    v_exp_f32 v50, v50
    v_exp_f32 v51, v51
    v_exp_f32 v52, v52
    v_exp_f32 v53, v53
    v_exp_f32 v54, v54
    v_exp_f32 v55, v55
    v_pk_fma_f32 v[40:41], v[40:41], s[90:91], s[90:91] op_sel_hi:[1,0,0]
    v_pk_fma_f32 v[42:43], v[42:43], s[90:91], s[90:91] op_sel_hi:[1,0,0]
    v_pk_fma_f32 v[44:45], v[44:45], s[90:91], s[90:91] op_sel_hi:[1,0,0]
    v_pk_fma_f32 v[46:47], v[46:47], s[90:91], s[90:91] op_sel_hi:[1,0,0]
    v_pk_fma_f32 v[48:49], v[48:49], s[90:91], s[90:91] op_sel_hi:[1,0,0]
    v_pk_fma_f32 v[50:51], v[50:51], s[90:91], s[90:91] op_sel_hi:[1,0,0]
    v_pk_fma_f32 v[52:53], v[52:53], s[90:91], s[90:91] op_sel_hi:[1,0,0]
    v_pk_fma_f32 v[54:55], v[54:55], s[90:91], s[90:91] op_sel_hi:[1,0,0]
    v_rcp_f32 v40, v40
    v_rcp_f32 v41, v41
    v_rcp_f32 v42, v42
    v_rcp_f32 v43, v43
    v_rcp_f32 v44, v44
    v_rcp_f32 v45, v45
    v_rcp_f32 v46, v46
    v_rcp_f32 v47, v47
    v_rcp_f32 v48, v48
    v_rcp_f32 v49, v49
    v_rcp_f32 v50, v50
    v_rcp_f32 v51, v51
    v_rcp_f32 v52, v52
    v_rcp_f32 v53, v53
    v_rcp_f32 v54, v54
    v_rcp_f32 v55, v55
    v_pk_mul_f32 v[176:177], v[176:177], v[40:41]
    v_pk_mul_f32 v[178:179], v[178:179], v[42:43]
    v_pk_mul_f32 v[180:181], v[180:181], v[44:45]
    v_pk_mul_f32 v[182:183], v[182:183], v[46:47]
    v_pk_mul_f32 v[184:185], v[184:185], v[48:49]
    v_pk_mul_f32 v[186:187], v[186:187], v[50:51]
    v_pk_mul_f32 v[188:189], v[188:189], v[52:53]
    v_pk_mul_f32 v[190:191], v[190:191], v[54:55]
    v_cvt_pk_f16_f32 v56, v176, v177
    v_cvt_pk_f16_f32 v57, v178, v179
    v_cvt_pk_f16_f32 v58, v180, v181
    v_cvt_pk_f16_f32 v59, v182, v183
    buffer_store_dwordx4 v[56:59], v11, s[8:11], s56 offen offset:0 sc0 sc1
    v_cvt_pk_f16_f32 v60, v184, v185
    v_cvt_pk_f16_f32 v61, v186, v187
    v_cvt_pk_f16_f32 v62, v188, v189
    v_cvt_pk_f16_f32 v63, v190, v191
    buffer_store_dwordx4 v[60:63], v11, s[8:11], s57 offen offset:0 sc0 sc1
    v_pk_fma_f32 v[192:193], v[192:193], v[24:25], v[32:33]
    v_pk_fma_f32 v[194:195], v[194:195], v[26:27], v[34:35]
    v_pk_fma_f32 v[196:197], v[196:197], v[28:29], v[36:37]
    v_pk_fma_f32 v[198:199], v[198:199], v[30:31], v[38:39]
    v_pk_fma_f32 v[200:201], v[200:201], v[24:25], v[32:33]
    v_pk_fma_f32 v[202:203], v[202:203], v[26:27], v[34:35]
    v_pk_fma_f32 v[204:205], v[204:205], v[28:29], v[36:37]
    v_pk_fma_f32 v[206:207], v[206:207], v[30:31], v[38:39]
    v_pk_mul_f32 v[40:41], v[192:193], s[92:93] op_sel:[0,1]
    v_pk_mul_f32 v[42:43], v[194:195], s[92:93] op_sel:[0,1]
    v_pk_mul_f32 v[44:45], v[196:197], s[92:93] op_sel:[0,1]
    v_pk_mul_f32 v[46:47], v[198:199], s[92:93] op_sel:[0,1]
    v_pk_mul_f32 v[48:49], v[200:201], s[92:93] op_sel:[0,1]
    v_pk_mul_f32 v[50:51], v[202:203], s[92:93] op_sel:[0,1]
    v_pk_mul_f32 v[52:53], v[204:205], s[92:93] op_sel:[0,1]
    v_pk_mul_f32 v[54:55], v[206:207], s[92:93] op_sel:[0,1]
    v_exp_f32 v40, v40
    v_exp_f32 v41, v41
    v_exp_f32 v42, v42
    v_exp_f32 v43, v43
    v_exp_f32 v44, v44
    v_exp_f32 v45, v45
    v_exp_f32 v46, v46
    v_exp_f32 v47, v47
    v_exp_f32 v48, v48
    v_exp_f32 v49, v49
    v_exp_f32 v50, v50
    v_exp_f32 v51, v51
    v_exp_f32 v52, v52
    v_exp_f32 v53, v53
    v_exp_f32 v54, v54
    v_exp_f32 v55, v55
    v_pk_fma_f32 v[40:41], v[40:41], s[90:91], s[90:91] op_sel_hi:[1,0,0]
    v_pk_fma_f32 v[42:43], v[42:43], s[90:91], s[90:91] op_sel_hi:[1,0,0]
    v_pk_fma_f32 v[44:45], v[44:45], s[90:91], s[90:91] op_sel_hi:[1,0,0]
    v_pk_fma_f32 v[46:47], v[46:47], s[90:91], s[90:91] op_sel_hi:[1,0,0]
    v_pk_fma_f32 v[48:49], v[48:49], s[90:91], s[90:91] op_sel_hi:[1,0,0]
    v_pk_fma_f32 v[50:51], v[50:51], s[90:91], s[90:91] op_sel_hi:[1,0,0]
    v_pk_fma_f32 v[52:53], v[52:53], s[90:91], s[90:91] op_sel_hi:[1,0,0]
    v_pk_fma_f32 v[54:55], v[54:55], s[90:91], s[90:91] op_sel_hi:[1,0,0]
    v_rcp_f32 v40, v40
    v_rcp_f32 v41, v41
    v_rcp_f32 v42, v42
    v_rcp_f32 v43, v43
    v_rcp_f32 v44, v44
    v_rcp_f32 v45, v45
    v_rcp_f32 v46, v46
    v_rcp_f32 v47, v47
    v_rcp_f32 v48, v48
    v_rcp_f32 v49, v49
    v_rcp_f32 v50, v50
    v_rcp_f32 v51, v51
    v_rcp_f32 v52, v52
    v_rcp_f32 v53, v53
    v_rcp_f32 v54, v54
    v_rcp_f32 v55, v55
    v_pk_mul_f32 v[192:193], v[192:193], v[40:41]
    v_pk_mul_f32 v[194:195], v[194:195], v[42:43]
    v_pk_mul_f32 v[196:197], v[196:197], v[44:45]
    v_pk_mul_f32 v[198:199], v[198:199], v[46:47]
    v_pk_mul_f32 v[200:201], v[200:201], v[48:49]
    v_pk_mul_f32 v[202:203], v[202:203], v[50:51]
    v_pk_mul_f32 v[204:205], v[204:205], v[52:53]
    v_pk_mul_f32 v[206:207], v[206:207], v[54:55]
    v_cvt_pk_f16_f32 v64, v192, v193
    v_cvt_pk_f16_f32 v65, v194, v195
    v_cvt_pk_f16_f32 v66, v196, v197
    v_cvt_pk_f16_f32 v67, v198, v199
    buffer_store_dwordx4 v[64:67], v11, s[8:11], s56 offen offset:1024 sc0 sc1
    v_cvt_pk_f16_f32 v68, v200, v201
    v_cvt_pk_f16_f32 v69, v202, v203
    v_cvt_pk_f16_f32 v70, v204, v205
    v_cvt_pk_f16_f32 v71, v206, v207
    buffer_store_dwordx4 v[68:71], v11, s[8:11], s57 offen offset:1024 sc0 sc1
    s_branch L_conv
L_epi2:
    s_cmp_ge_u32 s43, 4
    s_cbranch_scc1 L_haveres
    s_lshl_b32 s3, s43, 12
    s_add_u32 s3, s3, 133696
    v_add_u32 v10, s3, v6
    ds_read_b128 v[208:211], v10 offset:0
    ds_read_b128 v[212:215], v10 offset:1024
    ds_read_b128 v[216:219], v10 offset:2048
    ds_read_b128 v[220:223], v10 offset:3072
L_haveres:
    s_lshl_b32 s3, s43, 2
    s_mul_i32 s3, s3, 1040
    v_add_u32 v10, s3, v6
    v_add_u32 v11, 66560, v10
    ds_read_b128 v[112:115], v10 offset:0
    ds_read_b128 v[116:119], v10 offset:33280
    ds_read_b128 v[120:123], v11 offset:0
    ds_read_b128 v[124:127], v11 offset:33280
    ds_read_b128 v[128:131], v10 offset:1040
    ds_read_b128 v[132:135], v10 offset:34320
    ds_read_b128 v[136:139], v11 offset:1040
    ds_read_b128 v[140:143], v11 offset:34320
    ds_read_b128 v[144:147], v10 offset:2080
    ds_read_b128 v[148:151], v10 offset:35360
    ds_read_b128 v[152:155], v11 offset:2080
    ds_read_b128 v[156:159], v11 offset:35360
    ds_read_b128 v[160:163], v10 offset:3120
    ds_read_b128 v[164:167], v10 offset:36400
    ds_read_b128 v[168:171], v11 offset:3120
    ds_read_b128 v[172:175], v11 offset:36400
    s_waitcnt lgkmcnt(15)
    v_lshlrev_b32 v48, 16, v208
    v_and_b32 v56, 0xffff0000, v208
    v_lshlrev_b32 v64, 16, v209
    v_and_b32 v72, 0xffff0000, v209
    v_lshlrev_b32 v52, 16, v210
    v_and_b32 v60, 0xffff0000, v210
    v_lshlrev_b32 v68, 16, v211
    v_and_b32 v76, 0xffff0000, v211
    v_lshlrev_b32 v49, 16, v212
    v_and_b32 v57, 0xffff0000, v212
    v_lshlrev_b32 v65, 16, v213
    v_and_b32 v73, 0xffff0000, v213
    v_lshlrev_b32 v53, 16, v214
    v_and_b32 v61, 0xffff0000, v214
    v_lshlrev_b32 v69, 16, v215
    v_and_b32 v77, 0xffff0000, v215
    v_lshlrev_b32 v50, 16, v216
    v_and_b32 v58, 0xffff0000, v216
    v_lshlrev_b32 v66, 16, v217
    v_and_b32 v74, 0xffff0000, v217
    v_lshlrev_b32 v54, 16, v218
    v_and_b32 v62, 0xffff0000, v218
    v_lshlrev_b32 v70, 16, v219
    v_and_b32 v78, 0xffff0000, v219
    v_lshlrev_b32 v51, 16, v220
    v_and_b32 v59, 0xffff0000, v220
    v_lshlrev_b32 v67, 16, v221
    v_and_b32 v75, 0xffff0000, v221
    v_lshlrev_b32 v55, 16, v222
    v_and_b32 v63, 0xffff0000, v222
    v_lshlrev_b32 v71, 16, v223
    v_and_b32 v79, 0xffff0000, v223
    s_waitcnt lgkmcnt(12)
    v_pk_add_f32 v[176:177], v[116:117], v[120:121]
    v_pk_add_f32 v[180:181], v[116:117], v[120:121] neg_lo:[0,1] neg_hi:[0,1]
    v_pk_fma_f32 v[112:113], v[112:113], s[90:91], v[48:49] op_sel_hi:[1,0,1]
    v_pk_fma_f32 v[124:125], v[124:125], s[90:91], v[52:53] op_sel_hi:[1,0,1] neg_lo:[1,0,0] neg_hi:[1,0,0]
    v_pk_fma_f32 v[176:177], v[176:177], s[90:91], v[112:113] op_sel:[0,1,0]
    v_pk_fma_f32 v[180:181], v[180:181], s[90:91], v[124:125] op_sel:[0,1,0]
    v_pk_add_f32 v[178:179], v[118:119], v[122:123]
    v_pk_add_f32 v[182:183], v[118:119], v[122:123] neg_lo:[0,1] neg_hi:[0,1]
    v_pk_fma_f32 v[114:115], v[114:115], s[90:91], v[50:51] op_sel_hi:[1,0,1]
    v_pk_fma_f32 v[126:127], v[126:127], s[90:91], v[54:55] op_sel_hi:[1,0,1] neg_lo:[1,0,0] neg_hi:[1,0,0]
    v_pk_fma_f32 v[178:179], v[178:179], s[90:91], v[114:115] op_sel:[0,1,0]
    v_pk_fma_f32 v[182:183], v[182:183], s[90:91], v[126:127] op_sel:[0,1,0]
    s_waitcnt lgkmcnt(8)
    v_pk_add_f32 v[184:185], v[132:133], v[136:137]
    v_pk_add_f32 v[188:189], v[132:133], v[136:137] neg_lo:[0,1] neg_hi:[0,1]
    v_pk_fma_f32 v[128:129], v[128:129], s[90:91], v[56:57] op_sel_hi:[1,0,1]
    v_pk_fma_f32 v[140:141], v[140:141], s[90:91], v[60:61] op_sel_hi:[1,0,1] neg_lo:[1,0,0] neg_hi:[1,0,0]
    v_pk_fma_f32 v[184:185], v[184:185], s[90:91], v[128:129] op_sel:[0,1,0]
    v_pk_fma_f32 v[188:189], v[188:189], s[90:91], v[140:141] op_sel:[0,1,0]
    v_pk_add_f32 v[186:187], v[134:135], v[138:139]
    v_pk_add_f32 v[190:191], v[134:135], v[138:139] neg_lo:[0,1] neg_hi:[0,1]
    v_pk_fma_f32 v[130:131], v[130:131], s[90:91], v[58:59] op_sel_hi:[1,0,1]
    v_pk_fma_f32 v[142:143], v[142:143], s[90:91], v[62:63] op_sel_hi:[1,0,1] neg_lo:[1,0,0] neg_hi:[1,0,0]
    v_pk_fma_f32 v[186:187], v[186:187], s[90:91], v[130:131] op_sel:[0,1,0]
    v_pk_fma_f32 v[190:191], v[190:191], s[90:91], v[142:143] op_sel:[0,1,0]
    s_waitcnt lgkmcnt(4)
    v_pk_add_f32 v[192:193], v[148:149], v[152:153]
    v_pk_add_f32 v[196:197], v[148:149], v[152:153] neg_lo:[0,1] neg_hi:[0,1]
    v_pk_fma_f32 v[144:145], v[144:145], s[90:91], v[64:65] op_sel_hi:[1,0,1]
    v_pk_fma_f32 v[156:157], v[156:157], s[90:91], v[68:69] op_sel_hi:[1,0,1] neg_lo:[1,0,0] neg_hi:[1,0,0]
    v_pk_fma_f32 v[192:193], v[192:193], s[90:91], v[144:145] op_sel:[0,1,0]
    v_pk_fma_f32 v[196:197], v[196:197], s[90:91], v[156:157] op_sel:[0,1,0]
    v_pk_add_f32 v[194:195], v[150:151], v[154:155]
    v_pk_add_f32 v[198:199], v[150:151], v[154:155] neg_lo:[0,1] neg_hi:[0,1]
    v_pk_fma_f32 v[146:147], v[146:147], s[90:91], v[66:67] op_sel_hi:[1,0,1]
    v_pk_fma_f32 v[158:159], v[158:159], s[90:91], v[70:71] op_sel_hi:[1,0,1] neg_lo:[1,0,0] neg_hi:[1,0,0]
    v_pk_fma_f32 v[194:195], v[194:195], s[90:91], v[146:147] op_sel:[0,1,0]
    v_pk_fma_f32 v[198:199], v[198:199], s[90:91], v[158:159] op_sel:[0,1,0]
    s_waitcnt lgkmcnt(0)
    v_pk_add_f32 v[200:201], v[164:165], v[168:169]
    v_pk_add_f32 v[204:205], v[164:165], v[168:169] neg_lo:[0,1] neg_hi:[0,1]
    v_pk_fma_f32 v[160:161], v[160:161], s[90:91], v[72:73] op_sel_hi:[1,0,1]
    v_pk_fma_f32 v[172:173], v[172:173], s[90:91], v[76:77] op_sel_hi:[1,0,1] neg_lo:[1,0,0] neg_hi:[1,0,0]
    v_pk_fma_f32 v[200:201], v[200:201], s[90:91], v[160:161] op_sel:[0,1,0]
    v_pk_fma_f32 v[204:205], v[204:205], s[90:91], v[172:173] op_sel:[0,1,0]
    v_pk_add_f32 v[202:203], v[166:167], v[170:171]
    v_pk_add_f32 v[206:207], v[166:167], v[170:171] neg_lo:[0,1] neg_hi:[0,1]
    v_pk_fma_f32 v[162:163], v[162:163], s[90:91], v[74:75] op_sel_hi:[1,0,1]
    v_pk_fma_f32 v[174:175], v[174:175], s[90:91], v[78:79] op_sel_hi:[1,0,1] neg_lo:[1,0,0] neg_hi:[1,0,0]
    v_pk_fma_f32 v[202:203], v[202:203], s[90:91], v[162:163] op_sel:[0,1,0]
    v_pk_fma_f32 v[206:207], v[206:207], s[90:91], v[174:175] op_sel:[0,1,0]
    s_mov_b32 s8, s82
    s_mov_b32 s9, s83
    s_mov_b32 s10, 0x800000
    s_mov_b32 s11, 0x20000
    v_cvt_pk_bf16_f32 v16, v176, v184
    v_cvt_pk_bf16_f32 v17, v192, v200
    buffer_store_dwordx2 v[16:17], v13, s[8:11], s60 offen offset:0 nt
    v_cvt_pk_bf16_f32 v18, v180, v188
    v_cvt_pk_bf16_f32 v19, v196, v204
    buffer_store_dwordx2 v[18:19], v13, s[8:11], s60 offen offset:128 nt
    v_cvt_pk_bf16_f32 v20, v177, v185
    v_cvt_pk_bf16_f32 v21, v193, v201
    buffer_store_dwordx2 v[20:21], v13, s[8:11], s61 offen offset:0 nt
    v_cvt_pk_bf16_f32 v22, v181, v189
    v_cvt_pk_bf16_f32 v23, v197, v205
    buffer_store_dwordx2 v[22:23], v13, s[8:11], s61 offen offset:128 nt
    v_cvt_pk_bf16_f32 v24, v178, v186
    v_cvt_pk_bf16_f32 v25, v194, v202
    buffer_store_dwordx2 v[24:25], v13, s[8:11], s62 offen offset:0 nt
    v_cvt_pk_bf16_f32 v26, v182, v190
    v_cvt_pk_bf16_f32 v27, v198, v206
    buffer_store_dwordx2 v[26:27], v13, s[8:11], s62 offen offset:128 nt
    v_cvt_pk_bf16_f32 v28, v179, v187
    v_cvt_pk_bf16_f32 v29, v195, v203
    buffer_store_dwordx2 v[28:29], v13, s[8:11], s63 offen offset:0 nt
    v_cvt_pk_bf16_f32 v30, v183, v191
    v_cvt_pk_bf16_f32 v31, v199, v207
    buffer_store_dwordx2 v[30:31], v13, s[8:11], s63 offen offset:128 nt
L_end:
    s_endpgm
L_codeend:
.section .rodata,"a"
.p2align 6
.amdhsa_kernel standalone__adm_resblock__diffusion_kernel
  .amdhsa_next_free_vgpr 256
  .amdhsa_next_free_sgpr 102
  .amdhsa_accum_offset 256
  .amdhsa_group_segment_fixed_size 0
  .amdhsa_kernarg_size 96
  .amdhsa_user_sgpr_count 2
  .amdhsa_user_sgpr_kernarg_segment_ptr 1
  .amdhsa_system_sgpr_workgroup_id_x 1
  .amdhsa_float_denorm_mode_32 3
  .amdhsa_float_denorm_mode_16_64 3
.end_amdhsa_kernel
```
